```python
import torch

def _softmax(x, axis=-1):
    return torch.softmax(x, dim=axis)
def _gelu(x):
    return torch.nn.functional.gelu(x, approximate="tanh")
def _silu(x):
    return torch.nn.functional.silu(x)
def _sigmoid(x):
    return torch.sigmoid(x)
def _layernorm(x, axis=-1, eps=1e-5):
    m = x.mean(dim=axis, keepdim=True)
    v = x.var(dim=axis, keepdim=True, unbiased=False)
    return (x - m) / torch.sqrt(v + eps)
def _scatter_add(tgt, idx, src, axis=0):
    return tgt.clone().index_add_(axis, idx, src)
def _segment_sum(src, seg, n):
    out = torch.zeros((n,) + src.shape[1:], dtype=src.dtype)
    return out.index_add_(0, seg, src)
def _pad(x, pw):
    flat = tuple(v for pair in reversed(pw) for v in pair)
    return torch.nn.functional.pad(x, flat)

kernel_name = 'concat_heads__mha_block__softmax_full_mha__prompt'

def setup_inputs():

    _w = (lambda a: (lambda t: t.to(torch.bfloat16) if t.is_floating_point() else t)(torch.as_tensor(a)))
    def _A_setup():
        B, S, D, H = 1, 2048, 448, 16
        return {
            "x": _w((lambda *s: torch.randn(*s, dtype=torch.bfloat16) * 0.2)(B, S, D)),
            "wqkv": _w((lambda *s: torch.randn(*s, dtype=torch.bfloat16) * 0.2)(D, 3 * D)),
            "wo": _w((lambda *s: torch.randn(*s, dtype=torch.bfloat16) * 0.05)(D, D)),
        }
    _A_in = _A_setup()

    def _B_setup():
        B, S, D = 1, 2048, 448
        return {
            "x": _w((lambda *s: torch.randn(*s, dtype=torch.bfloat16) * 0.2)(B, S, D)),
            "wqkv": _w((lambda *s: torch.randn(*s, dtype=torch.bfloat16) * 0.2)(D, 3 * D)),
            "wo": _w((lambda *s: torch.randn(*s, dtype=torch.bfloat16) * 0.05)(D, D)),
        }
    _B_in = _B_setup()

    return {
        "A_x": _A_in["x"],
        "A_wqkv": _A_in["wqkv"],
        "A_wo": _A_in["wo"],
        "B_x": _B_in["x"],
        "B_wqkv": _B_in["wqkv"],
        "B_wo": _B_in["wo"],
    }

def reference(A_x, A_wqkv, A_wo, B_x, B_wqkv, B_wo):
    def _A_ref(x, wqkv, wo):
        B, S, D = x.shape
        H = 16
        Dh = D // H
        qkv = (lambda x, *d: x.permute(*d))((x @ wqkv).reshape(B, S, 3, H, Dh), 2, 0, 3, 1, 4)
        q, k, v = qkv[0], qkv[1], qkv[2]
        scores = torch.einsum("bhqd,bhkd->bhqk", q, k) * (Dh ** -0.5)
        p = _softmax(scores, axis=-1)
        o = torch.einsum("bhqk,bhkd->bhqd", p, v)
        return (lambda x, *d: x.permute(*d))(o, 0, 2, 1, 3).reshape(B, S, D) @ wo

    def _B_ref(x, wqkv, wo):
        B, S, D = x.shape
        H = 16; Dh = D // H
        qkv = (lambda x, *d: x.permute(*d))((x @ wqkv).reshape(B, S, 3, H, Dh), 2, 0, 3, 1, 4)
        q, k, v = qkv[0], qkv[1], qkv[2]
        scale = Dh ** -0.5
        scores = torch.einsum("bhqd,bhkd->bhqk", q, k) * scale
        p = _softmax(scores, axis=-1)
        o = torch.einsum("bhqk,bhkd->bhqd", p, v)
        return (lambda x, *d: x.permute(*d))(o, 0, 2, 1, 3).reshape(B, S, D) @ wo

    a = _A_ref(A_x, A_wqkv, A_wo)
    b = _B_ref(B_x, B_wqkv, B_wo)
    return torch.concatenate([a, b], axis=-1)
```

```asm
; @launch kernel=qkv_kernel grid=(192,1,1) block=(256,1,1) lds=57344
; @launch kernel=attn_kernel grid=(512,1,1) block=(256,1,1) lds=32768
; @launch kernel=oproj_kernel grid=(224,1,1) block=(256,1,1) lds=16384
.amdgcn_target "amdgcn-amd-amdhsa--gfx950"
.text
.globl qkv_kernel
.p2align 8
.type qkv_kernel,@function
qkv_kernel:
s_cmp_ge_u32 s2, 192
s_cbranch_scc1 qkv_kernel_end
s_cmp_ge_u32 s2, 96
s_cselect_b32 s20, 1, 0
s_mul_i32 s23, s20, 96
s_sub_u32 s23, s2, s23
s_and_b32 s21, s23, 15
s_lshr_b32 s22, s23, 4
s_mul_i32 s24, s20, 24
s_load_dwordx2 s[28:29], s[0:1], 64
s_load_dwordx2 s[30:31], s[0:1], 48
s_load_dwordx2 s[26:27], s[0:1], s24
s_add_u32 s25, s24, 8
s_load_dwordx2 s[32:33], s[0:1], s25
v_and_b32 v1, 63, v0
v_lshrrev_b32 v2, 6, v0
s_nop 0
v_readfirstlane_b32 s34, v2
v_and_b32 v3, 31, v1
v_lshrrev_b32 v4, 5, v1
s_waitcnt lgkmcnt(0)
s_mov_b32 s4, s26
s_and_b32 s5, s27, 0xffff
s_mov_b32 s6, 1835008
s_mov_b32 s7, 0x00020000
s_mov_b32 s8, s32
s_and_b32 s9, s33, 0xffff
s_mov_b32 s10, 1204224
s_mov_b32 s11, 0x00020000
s_mov_b32 s12, s28
s_and_b32 s13, s29, 0xffff
s_mov_b32 s14, 16777216
s_mov_b32 s15, 0x00020000
s_mov_b32 s16, s30
s_and_b32 s17, s31, 0xffff
s_mov_b32 s18, 3670016
s_mov_b32 s19, 0x00020000
s_lshl_b32 s35, s21, 2
s_add_u32 s35, s35, s34
s_lshl_b32 s36, s35, 5
v_add_u32 v5, s36, v3
v_mul_u32_u24 v5, 896, v5
v_lshl_add_u32 v5, v4, 4, v5
s_mul_i32 s37, s22, 448
s_lshl_b32 s38, s34, 6
s_mul_i32 s39, s34, 448
s_add_u32 s39, s39, 0
v_add_u32 v6, s39, v1
v_mul_u32_u24 v7, 2341, v6
v_lshrrev_b32 v7, 16, v7
v_mul_u32_u24 v8, 28, v7
v_sub_u32 v8, v6, v8
v_mul_u32_u24 v7, 2688, v7
v_lshl_add_u32 v7, v8, 4, v7
v_add_u32 v128, s37, v7
s_mul_i32 s39, s34, 448
s_add_u32 s39, s39, 64
v_add_u32 v6, s39, v1
v_mul_u32_u24 v7, 2341, v6
v_lshrrev_b32 v7, 16, v7
v_mul_u32_u24 v8, 28, v7
v_sub_u32 v8, v6, v8
v_mul_u32_u24 v7, 2688, v7
v_lshl_add_u32 v7, v8, 4, v7
v_add_u32 v129, s37, v7
s_mul_i32 s39, s34, 448
s_add_u32 s39, s39, 128
v_add_u32 v6, s39, v1
v_mul_u32_u24 v7, 2341, v6
v_lshrrev_b32 v7, 16, v7
v_mul_u32_u24 v8, 28, v7
v_sub_u32 v8, v6, v8
v_mul_u32_u24 v7, 2688, v7
v_lshl_add_u32 v7, v8, 4, v7
v_add_u32 v130, s37, v7
s_mul_i32 s39, s34, 448
s_add_u32 s39, s39, 192
v_add_u32 v6, s39, v1
v_mul_u32_u24 v7, 2341, v6
v_lshrrev_b32 v7, 16, v7
v_mul_u32_u24 v8, 28, v7
v_sub_u32 v8, v6, v8
v_mul_u32_u24 v7, 2688, v7
v_lshl_add_u32 v7, v8, 4, v7
v_add_u32 v131, s37, v7
s_mul_i32 s39, s34, 448
s_add_u32 s39, s39, 256
v_add_u32 v6, s39, v1
v_mul_u32_u24 v7, 2341, v6
v_lshrrev_b32 v7, 16, v7
v_mul_u32_u24 v8, 28, v7
v_sub_u32 v8, v6, v8
v_mul_u32_u24 v7, 2688, v7
v_lshl_add_u32 v7, v8, 4, v7
v_add_u32 v132, s37, v7
s_mul_i32 s39, s34, 448
s_add_u32 s39, s39, 320
v_add_u32 v6, s39, v1
v_mul_u32_u24 v7, 2341, v6
v_lshrrev_b32 v7, 16, v7
v_mul_u32_u24 v8, 28, v7
v_sub_u32 v8, v6, v8
v_mul_u32_u24 v7, 2688, v7
v_lshl_add_u32 v7, v8, 4, v7
v_add_u32 v133, s37, v7
s_mul_i32 s39, s34, 448
s_add_u32 s39, s39, 384
v_add_u32 v6, s39, v1
v_mul_u32_u24 v7, 2341, v6
v_lshrrev_b32 v7, 16, v7
v_mul_u32_u24 v8, 28, v7
v_sub_u32 v8, v6, v8
v_mul_u32_u24 v7, 2688, v7
v_lshl_add_u32 v7, v8, 4, v7
v_add_u32 v134, s37, v7
s_mov_b32 s40, 0
s_mul_i32 s39, s34, 7168
s_add_u32 s39, s39, 0
s_mov_b32 m0, s39
s_nop 0
buffer_load_dwordx4 v128, s[8:11], s40 offen lds
s_mul_i32 s39, s34, 7168
s_add_u32 s39, s39, 1024
s_mov_b32 m0, s39
s_nop 0
buffer_load_dwordx4 v129, s[8:11], s40 offen lds
s_mul_i32 s39, s34, 7168
s_add_u32 s39, s39, 2048
s_mov_b32 m0, s39
s_nop 0
buffer_load_dwordx4 v130, s[8:11], s40 offen lds
s_mul_i32 s39, s34, 7168
s_add_u32 s39, s39, 3072
s_mov_b32 m0, s39
s_nop 0
buffer_load_dwordx4 v131, s[8:11], s40 offen lds
s_mul_i32 s39, s34, 7168
s_add_u32 s39, s39, 4096
s_mov_b32 m0, s39
s_nop 0
buffer_load_dwordx4 v132, s[8:11], s40 offen lds
s_mul_i32 s39, s34, 7168
s_add_u32 s39, s39, 5120
s_mov_b32 m0, s39
s_nop 0
buffer_load_dwordx4 v133, s[8:11], s40 offen lds
s_mul_i32 s39, s34, 7168
s_add_u32 s39, s39, 6144
s_mov_b32 m0, s39
s_nop 0
buffer_load_dwordx4 v134, s[8:11], s40 offen lds
buffer_load_dwordx4 v[16:19], v5, s[4:7], 0 offen offset:0
buffer_load_dwordx4 v[20:23], v5, s[4:7], 0 offen offset:32
buffer_load_dwordx4 v[24:27], v5, s[4:7], 0 offen offset:64
buffer_load_dwordx4 v[28:31], v5, s[4:7], 0 offen offset:96
buffer_load_dwordx4 v[32:35], v5, s[4:7], 0 offen offset:128
buffer_load_dwordx4 v[36:39], v5, s[4:7], 0 offen offset:160
buffer_load_dwordx4 v[40:43], v5, s[4:7], 0 offen offset:192
buffer_load_dwordx4 v[44:47], v5, s[4:7], 0 offen offset:224
buffer_load_dwordx4 v[48:51], v5, s[4:7], 0 offen offset:256
buffer_load_dwordx4 v[52:55], v5, s[4:7], 0 offen offset:288
buffer_load_dwordx4 v[56:59], v5, s[4:7], 0 offen offset:320
buffer_load_dwordx4 v[60:63], v5, s[4:7], 0 offen offset:352
buffer_load_dwordx4 v[64:67], v5, s[4:7], 0 offen offset:384
buffer_load_dwordx4 v[68:71], v5, s[4:7], 0 offen offset:416
buffer_load_dwordx4 v[72:75], v5, s[4:7], 0 offen offset:448
buffer_load_dwordx4 v[76:79], v5, s[4:7], 0 offen offset:480
buffer_load_dwordx4 v[80:83], v5, s[4:7], 0 offen offset:512
buffer_load_dwordx4 v[84:87], v5, s[4:7], 0 offen offset:544
buffer_load_dwordx4 v[88:91], v5, s[4:7], 0 offen offset:576
buffer_load_dwordx4 v[92:95], v5, s[4:7], 0 offen offset:608
buffer_load_dwordx4 v[96:99], v5, s[4:7], 0 offen offset:640
buffer_load_dwordx4 v[100:103], v5, s[4:7], 0 offen offset:672
buffer_load_dwordx4 v[104:107], v5, s[4:7], 0 offen offset:704
buffer_load_dwordx4 v[108:111], v5, s[4:7], 0 offen offset:736
buffer_load_dwordx4 v[112:115], v5, s[4:7], 0 offen offset:768
buffer_load_dwordx4 v[116:119], v5, s[4:7], 0 offen offset:800
buffer_load_dwordx4 v[120:123], v5, s[4:7], 0 offen offset:832
buffer_load_dwordx4 v[124:127], v5, s[4:7], 0 offen offset:864
v_and_b32 v6, 15, v1
v_lshrrev_b32 v7, 2, v6
v_lshl_add_u32 v7, v4, 3, v7
v_mul_u32_u24 v9, 448, v7
v_and_b32 v6, 3, v1
v_lshl_add_u32 v9, v6, 3, v9
v_bfe_u32 v6, v1, 4, 1
v_lshl_add_u32 v9, v6, 5, v9
v_accvgpr_write_b32 a0, 0
v_accvgpr_write_b32 a1, 0
v_accvgpr_write_b32 a2, 0
v_accvgpr_write_b32 a3, 0
v_accvgpr_write_b32 a4, 0
v_accvgpr_write_b32 a5, 0
v_accvgpr_write_b32 a6, 0
v_accvgpr_write_b32 a7, 0
v_accvgpr_write_b32 a8, 0
v_accvgpr_write_b32 a9, 0
v_accvgpr_write_b32 a10, 0
v_accvgpr_write_b32 a11, 0
v_accvgpr_write_b32 a12, 0
v_accvgpr_write_b32 a13, 0
v_accvgpr_write_b32 a14, 0
v_accvgpr_write_b32 a15, 0
v_accvgpr_write_b32 a16, 0
v_accvgpr_write_b32 a17, 0
v_accvgpr_write_b32 a18, 0
v_accvgpr_write_b32 a19, 0
v_accvgpr_write_b32 a20, 0
v_accvgpr_write_b32 a21, 0
v_accvgpr_write_b32 a22, 0
v_accvgpr_write_b32 a23, 0
v_accvgpr_write_b32 a24, 0
v_accvgpr_write_b32 a25, 0
v_accvgpr_write_b32 a26, 0
v_accvgpr_write_b32 a27, 0
v_accvgpr_write_b32 a28, 0
v_accvgpr_write_b32 a29, 0
v_accvgpr_write_b32 a30, 0
v_accvgpr_write_b32 a31, 0
v_accvgpr_write_b32 a32, 0
v_accvgpr_write_b32 a33, 0
v_accvgpr_write_b32 a34, 0
v_accvgpr_write_b32 a35, 0
v_accvgpr_write_b32 a36, 0
v_accvgpr_write_b32 a37, 0
v_accvgpr_write_b32 a38, 0
v_accvgpr_write_b32 a39, 0
v_accvgpr_write_b32 a40, 0
v_accvgpr_write_b32 a41, 0
v_accvgpr_write_b32 a42, 0
v_accvgpr_write_b32 a43, 0
v_accvgpr_write_b32 a44, 0
v_accvgpr_write_b32 a45, 0
v_accvgpr_write_b32 a46, 0
v_accvgpr_write_b32 a47, 0
v_accvgpr_write_b32 a48, 0
v_accvgpr_write_b32 a49, 0
v_accvgpr_write_b32 a50, 0
v_accvgpr_write_b32 a51, 0
v_accvgpr_write_b32 a52, 0
v_accvgpr_write_b32 a53, 0
v_accvgpr_write_b32 a54, 0
v_accvgpr_write_b32 a55, 0
v_accvgpr_write_b32 a56, 0
v_accvgpr_write_b32 a57, 0
v_accvgpr_write_b32 a58, 0
v_accvgpr_write_b32 a59, 0
v_accvgpr_write_b32 a60, 0
v_accvgpr_write_b32 a61, 0
v_accvgpr_write_b32 a62, 0
v_accvgpr_write_b32 a63, 0
v_accvgpr_write_b32 a64, 0
v_accvgpr_write_b32 a65, 0
v_accvgpr_write_b32 a66, 0
v_accvgpr_write_b32 a67, 0
v_accvgpr_write_b32 a68, 0
v_accvgpr_write_b32 a69, 0
v_accvgpr_write_b32 a70, 0
v_accvgpr_write_b32 a71, 0
v_accvgpr_write_b32 a72, 0
v_accvgpr_write_b32 a73, 0
v_accvgpr_write_b32 a74, 0
v_accvgpr_write_b32 a75, 0
v_accvgpr_write_b32 a76, 0
v_accvgpr_write_b32 a77, 0
v_accvgpr_write_b32 a78, 0
v_accvgpr_write_b32 a79, 0
v_accvgpr_write_b32 a80, 0
v_accvgpr_write_b32 a81, 0
v_accvgpr_write_b32 a82, 0
v_accvgpr_write_b32 a83, 0
v_accvgpr_write_b32 a84, 0
v_accvgpr_write_b32 a85, 0
v_accvgpr_write_b32 a86, 0
v_accvgpr_write_b32 a87, 0
v_accvgpr_write_b32 a88, 0
v_accvgpr_write_b32 a89, 0
v_accvgpr_write_b32 a90, 0
v_accvgpr_write_b32 a91, 0
v_accvgpr_write_b32 a92, 0
v_accvgpr_write_b32 a93, 0
v_accvgpr_write_b32 a94, 0
v_accvgpr_write_b32 a95, 0
v_accvgpr_write_b32 a96, 0
v_accvgpr_write_b32 a97, 0
v_accvgpr_write_b32 a98, 0
v_accvgpr_write_b32 a99, 0
v_accvgpr_write_b32 a100, 0
v_accvgpr_write_b32 a101, 0
v_accvgpr_write_b32 a102, 0
v_accvgpr_write_b32 a103, 0
v_accvgpr_write_b32 a104, 0
v_accvgpr_write_b32 a105, 0
v_accvgpr_write_b32 a106, 0
v_accvgpr_write_b32 a107, 0
v_accvgpr_write_b32 a108, 0
v_accvgpr_write_b32 a109, 0
v_accvgpr_write_b32 a110, 0
v_accvgpr_write_b32 a111, 0
s_cmp_ge_u32 s22, 4
s_cselect_b32 s41, 1, 0
s_waitcnt vmcnt(0)
s_barrier
s_mov_b32 s40, 172032
s_mul_i32 s39, s34, 7168
s_add_u32 s39, s39, 28672
s_mov_b32 m0, s39
s_nop 0
buffer_load_dwordx4 v128, s[8:11], s40 offen lds
s_mul_i32 s39, s34, 7168
s_add_u32 s39, s39, 29696
s_mov_b32 m0, s39
s_nop 0
buffer_load_dwordx4 v129, s[8:11], s40 offen lds
s_mul_i32 s39, s34, 7168
s_add_u32 s39, s39, 30720
s_mov_b32 m0, s39
s_nop 0
buffer_load_dwordx4 v130, s[8:11], s40 offen lds
s_mul_i32 s39, s34, 7168
s_add_u32 s39, s39, 31744
s_mov_b32 m0, s39
s_nop 0
buffer_load_dwordx4 v131, s[8:11], s40 offen lds
s_mul_i32 s39, s34, 7168
s_add_u32 s39, s39, 32768
s_mov_b32 m0, s39
s_nop 0
buffer_load_dwordx4 v132, s[8:11], s40 offen lds
s_mul_i32 s39, s34, 7168
s_add_u32 s39, s39, 33792
s_mov_b32 m0, s39
s_nop 0
buffer_load_dwordx4 v133, s[8:11], s40 offen lds
s_mul_i32 s39, s34, 7168
s_add_u32 s39, s39, 34816
s_mov_b32 m0, s39
s_nop 0
buffer_load_dwordx4 v134, s[8:11], s40 offen lds
s_cmp_eq_u32 s41, 1
s_cbranch_scc1 qkv_kernel_v0
ds_read_b64_tr_b16 v[136:137], v9 offset:0
ds_read_b64_tr_b16 v[138:139], v9 offset:1792
ds_read_b64_tr_b16 v[140:141], v9 offset:64
ds_read_b64_tr_b16 v[142:143], v9 offset:1856
ds_read_b64_tr_b16 v[144:145], v9 offset:128
ds_read_b64_tr_b16 v[146:147], v9 offset:1920
ds_read_b64_tr_b16 v[148:149], v9 offset:192
ds_read_b64_tr_b16 v[150:151], v9 offset:1984
ds_read_b64_tr_b16 v[152:153], v9 offset:256
ds_read_b64_tr_b16 v[154:155], v9 offset:2048
ds_read_b64_tr_b16 v[156:157], v9 offset:320
ds_read_b64_tr_b16 v[158:159], v9 offset:2112
ds_read_b64_tr_b16 v[160:161], v9 offset:384
ds_read_b64_tr_b16 v[162:163], v9 offset:2176
ds_read_b64_tr_b16 v[164:165], v9 offset:7168
ds_read_b64_tr_b16 v[166:167], v9 offset:8960
ds_read_b64_tr_b16 v[168:169], v9 offset:7232
ds_read_b64_tr_b16 v[170:171], v9 offset:9024
ds_read_b64_tr_b16 v[172:173], v9 offset:7296
ds_read_b64_tr_b16 v[174:175], v9 offset:9088
ds_read_b64_tr_b16 v[176:177], v9 offset:7360
ds_read_b64_tr_b16 v[178:179], v9 offset:9152
ds_read_b64_tr_b16 v[180:181], v9 offset:7424
ds_read_b64_tr_b16 v[182:183], v9 offset:9216
ds_read_b64_tr_b16 v[184:185], v9 offset:7488
ds_read_b64_tr_b16 v[186:187], v9 offset:9280
ds_read_b64_tr_b16 v[188:189], v9 offset:7552
ds_read_b64_tr_b16 v[190:191], v9 offset:9344
s_waitcnt lgkmcnt(14)
v_mfma_f32_32x32x16_bf16 a[0:15], v[136:139], v[16:19], a[0:15]
v_mfma_f32_32x32x16_bf16 a[16:31], v[140:143], v[16:19], a[16:31]
v_mfma_f32_32x32x16_bf16 a[32:47], v[144:147], v[16:19], a[32:47]
v_mfma_f32_32x32x16_bf16 a[48:63], v[148:151], v[16:19], a[48:63]
v_mfma_f32_32x32x16_bf16 a[64:79], v[152:155], v[16:19], a[64:79]
v_mfma_f32_32x32x16_bf16 a[80:95], v[156:159], v[16:19], a[80:95]
v_mfma_f32_32x32x16_bf16 a[96:111], v[160:163], v[16:19], a[96:111]
ds_read_b64_tr_b16 v[136:137], v9 offset:14336
ds_read_b64_tr_b16 v[138:139], v9 offset:16128
ds_read_b64_tr_b16 v[140:141], v9 offset:14400
ds_read_b64_tr_b16 v[142:143], v9 offset:16192
ds_read_b64_tr_b16 v[144:145], v9 offset:14464
ds_read_b64_tr_b16 v[146:147], v9 offset:16256
ds_read_b64_tr_b16 v[148:149], v9 offset:14528
ds_read_b64_tr_b16 v[150:151], v9 offset:16320
ds_read_b64_tr_b16 v[152:153], v9 offset:14592
ds_read_b64_tr_b16 v[154:155], v9 offset:16384
ds_read_b64_tr_b16 v[156:157], v9 offset:14656
ds_read_b64_tr_b16 v[158:159], v9 offset:16448
ds_read_b64_tr_b16 v[160:161], v9 offset:14720
ds_read_b64_tr_b16 v[162:163], v9 offset:16512
s_waitcnt lgkmcnt(14)
v_mfma_f32_32x32x16_bf16 a[0:15], v[164:167], v[20:23], a[0:15]
v_mfma_f32_32x32x16_bf16 a[16:31], v[168:171], v[20:23], a[16:31]
v_mfma_f32_32x32x16_bf16 a[32:47], v[172:175], v[20:23], a[32:47]
v_mfma_f32_32x32x16_bf16 a[48:63], v[176:179], v[20:23], a[48:63]
v_mfma_f32_32x32x16_bf16 a[64:79], v[180:183], v[20:23], a[64:79]
v_mfma_f32_32x32x16_bf16 a[80:95], v[184:187], v[20:23], a[80:95]
v_mfma_f32_32x32x16_bf16 a[96:111], v[188:191], v[20:23], a[96:111]
ds_read_b64_tr_b16 v[164:165], v9 offset:21504
ds_read_b64_tr_b16 v[166:167], v9 offset:23296
ds_read_b64_tr_b16 v[168:169], v9 offset:21568
ds_read_b64_tr_b16 v[170:171], v9 offset:23360
ds_read_b64_tr_b16 v[172:173], v9 offset:21632
ds_read_b64_tr_b16 v[174:175], v9 offset:23424
ds_read_b64_tr_b16 v[176:177], v9 offset:21696
ds_read_b64_tr_b16 v[178:179], v9 offset:23488
ds_read_b64_tr_b16 v[180:181], v9 offset:21760
ds_read_b64_tr_b16 v[182:183], v9 offset:23552
ds_read_b64_tr_b16 v[184:185], v9 offset:21824
ds_read_b64_tr_b16 v[186:187], v9 offset:23616
ds_read_b64_tr_b16 v[188:189], v9 offset:21888
ds_read_b64_tr_b16 v[190:191], v9 offset:23680
s_waitcnt lgkmcnt(14)
v_mfma_f32_32x32x16_bf16 a[0:15], v[136:139], v[24:27], a[0:15]
v_mfma_f32_32x32x16_bf16 a[16:31], v[140:143], v[24:27], a[16:31]
v_mfma_f32_32x32x16_bf16 a[32:47], v[144:147], v[24:27], a[32:47]
v_mfma_f32_32x32x16_bf16 a[48:63], v[148:151], v[24:27], a[48:63]
v_mfma_f32_32x32x16_bf16 a[64:79], v[152:155], v[24:27], a[64:79]
v_mfma_f32_32x32x16_bf16 a[80:95], v[156:159], v[24:27], a[80:95]
v_mfma_f32_32x32x16_bf16 a[96:111], v[160:163], v[24:27], a[96:111]
s_waitcnt lgkmcnt(0)
v_mfma_f32_32x32x16_bf16 a[0:15], v[164:167], v[28:31], a[0:15]
v_mfma_f32_32x32x16_bf16 a[16:31], v[168:171], v[28:31], a[16:31]
v_mfma_f32_32x32x16_bf16 a[32:47], v[172:175], v[28:31], a[32:47]
v_mfma_f32_32x32x16_bf16 a[48:63], v[176:179], v[28:31], a[48:63]
v_mfma_f32_32x32x16_bf16 a[64:79], v[180:183], v[28:31], a[64:79]
v_mfma_f32_32x32x16_bf16 a[80:95], v[184:187], v[28:31], a[80:95]
v_mfma_f32_32x32x16_bf16 a[96:111], v[188:191], v[28:31], a[96:111]
s_branch qkv_kernel_j0
qkv_kernel_v0:
ds_read_b64_tr_b16 v[136:137], v9 offset:0
ds_read_b64_tr_b16 v[138:139], v9 offset:1792
ds_read_b64_tr_b16 v[140:141], v9 offset:64
ds_read_b64_tr_b16 v[142:143], v9 offset:1856
ds_read_b64_tr_b16 v[144:145], v9 offset:128
ds_read_b64_tr_b16 v[146:147], v9 offset:1920
ds_read_b64_tr_b16 v[148:149], v9 offset:192
ds_read_b64_tr_b16 v[150:151], v9 offset:1984
ds_read_b64_tr_b16 v[152:153], v9 offset:256
ds_read_b64_tr_b16 v[154:155], v9 offset:2048
ds_read_b64_tr_b16 v[156:157], v9 offset:320
ds_read_b64_tr_b16 v[158:159], v9 offset:2112
ds_read_b64_tr_b16 v[160:161], v9 offset:384
ds_read_b64_tr_b16 v[162:163], v9 offset:2176
ds_read_b64_tr_b16 v[164:165], v9 offset:7168
ds_read_b64_tr_b16 v[166:167], v9 offset:8960
ds_read_b64_tr_b16 v[168:169], v9 offset:7232
ds_read_b64_tr_b16 v[170:171], v9 offset:9024
ds_read_b64_tr_b16 v[172:173], v9 offset:7296
ds_read_b64_tr_b16 v[174:175], v9 offset:9088
ds_read_b64_tr_b16 v[176:177], v9 offset:7360
ds_read_b64_tr_b16 v[178:179], v9 offset:9152
ds_read_b64_tr_b16 v[180:181], v9 offset:7424
ds_read_b64_tr_b16 v[182:183], v9 offset:9216
ds_read_b64_tr_b16 v[184:185], v9 offset:7488
ds_read_b64_tr_b16 v[186:187], v9 offset:9280
ds_read_b64_tr_b16 v[188:189], v9 offset:7552
ds_read_b64_tr_b16 v[190:191], v9 offset:9344
s_waitcnt lgkmcnt(14)
v_mfma_f32_32x32x16_bf16 a[0:15], v[16:19], v[136:139], a[0:15]
v_mfma_f32_32x32x16_bf16 a[16:31], v[16:19], v[140:143], a[16:31]
v_mfma_f32_32x32x16_bf16 a[32:47], v[16:19], v[144:147], a[32:47]
v_mfma_f32_32x32x16_bf16 a[48:63], v[16:19], v[148:151], a[48:63]
v_mfma_f32_32x32x16_bf16 a[64:79], v[16:19], v[152:155], a[64:79]
v_mfma_f32_32x32x16_bf16 a[80:95], v[16:19], v[156:159], a[80:95]
v_mfma_f32_32x32x16_bf16 a[96:111], v[16:19], v[160:163], a[96:111]
ds_read_b64_tr_b16 v[136:137], v9 offset:14336
ds_read_b64_tr_b16 v[138:139], v9 offset:16128
ds_read_b64_tr_b16 v[140:141], v9 offset:14400
ds_read_b64_tr_b16 v[142:143], v9 offset:16192
ds_read_b64_tr_b16 v[144:145], v9 offset:14464
ds_read_b64_tr_b16 v[146:147], v9 offset:16256
ds_read_b64_tr_b16 v[148:149], v9 offset:14528
ds_read_b64_tr_b16 v[150:151], v9 offset:16320
ds_read_b64_tr_b16 v[152:153], v9 offset:14592
ds_read_b64_tr_b16 v[154:155], v9 offset:16384
ds_read_b64_tr_b16 v[156:157], v9 offset:14656
ds_read_b64_tr_b16 v[158:159], v9 offset:16448
ds_read_b64_tr_b16 v[160:161], v9 offset:14720
ds_read_b64_tr_b16 v[162:163], v9 offset:16512
s_waitcnt lgkmcnt(14)
v_mfma_f32_32x32x16_bf16 a[0:15], v[20:23], v[164:167], a[0:15]
v_mfma_f32_32x32x16_bf16 a[16:31], v[20:23], v[168:171], a[16:31]
v_mfma_f32_32x32x16_bf16 a[32:47], v[20:23], v[172:175], a[32:47]
v_mfma_f32_32x32x16_bf16 a[48:63], v[20:23], v[176:179], a[48:63]
v_mfma_f32_32x32x16_bf16 a[64:79], v[20:23], v[180:183], a[64:79]
v_mfma_f32_32x32x16_bf16 a[80:95], v[20:23], v[184:187], a[80:95]
v_mfma_f32_32x32x16_bf16 a[96:111], v[20:23], v[188:191], a[96:111]
ds_read_b64_tr_b16 v[164:165], v9 offset:21504
ds_read_b64_tr_b16 v[166:167], v9 offset:23296
ds_read_b64_tr_b16 v[168:169], v9 offset:21568
ds_read_b64_tr_b16 v[170:171], v9 offset:23360
ds_read_b64_tr_b16 v[172:173], v9 offset:21632
ds_read_b64_tr_b16 v[174:175], v9 offset:23424
ds_read_b64_tr_b16 v[176:177], v9 offset:21696
ds_read_b64_tr_b16 v[178:179], v9 offset:23488
ds_read_b64_tr_b16 v[180:181], v9 offset:21760
ds_read_b64_tr_b16 v[182:183], v9 offset:23552
ds_read_b64_tr_b16 v[184:185], v9 offset:21824
ds_read_b64_tr_b16 v[186:187], v9 offset:23616
ds_read_b64_tr_b16 v[188:189], v9 offset:21888
ds_read_b64_tr_b16 v[190:191], v9 offset:23680
s_waitcnt lgkmcnt(14)
v_mfma_f32_32x32x16_bf16 a[0:15], v[24:27], v[136:139], a[0:15]
v_mfma_f32_32x32x16_bf16 a[16:31], v[24:27], v[140:143], a[16:31]
v_mfma_f32_32x32x16_bf16 a[32:47], v[24:27], v[144:147], a[32:47]
v_mfma_f32_32x32x16_bf16 a[48:63], v[24:27], v[148:151], a[48:63]
v_mfma_f32_32x32x16_bf16 a[64:79], v[24:27], v[152:155], a[64:79]
v_mfma_f32_32x32x16_bf16 a[80:95], v[24:27], v[156:159], a[80:95]
v_mfma_f32_32x32x16_bf16 a[96:111], v[24:27], v[160:163], a[96:111]
s_waitcnt lgkmcnt(0)
v_mfma_f32_32x32x16_bf16 a[0:15], v[28:31], v[164:167], a[0:15]
v_mfma_f32_32x32x16_bf16 a[16:31], v[28:31], v[168:171], a[16:31]
v_mfma_f32_32x32x16_bf16 a[32:47], v[28:31], v[172:175], a[32:47]
v_mfma_f32_32x32x16_bf16 a[48:63], v[28:31], v[176:179], a[48:63]
v_mfma_f32_32x32x16_bf16 a[64:79], v[28:31], v[180:183], a[64:79]
v_mfma_f32_32x32x16_bf16 a[80:95], v[28:31], v[184:187], a[80:95]
v_mfma_f32_32x32x16_bf16 a[96:111], v[28:31], v[188:191], a[96:111]
qkv_kernel_j0:
s_waitcnt vmcnt(0)
s_barrier
s_mov_b32 s40, 344064
s_mul_i32 s39, s34, 7168
s_add_u32 s39, s39, 0
s_mov_b32 m0, s39
s_nop 0
buffer_load_dwordx4 v128, s[8:11], s40 offen lds
s_mul_i32 s39, s34, 7168
s_add_u32 s39, s39, 1024
s_mov_b32 m0, s39
s_nop 0
buffer_load_dwordx4 v129, s[8:11], s40 offen lds
s_mul_i32 s39, s34, 7168
s_add_u32 s39, s39, 2048
s_mov_b32 m0, s39
s_nop 0
buffer_load_dwordx4 v130, s[8:11], s40 offen lds
s_mul_i32 s39, s34, 7168
s_add_u32 s39, s39, 3072
s_mov_b32 m0, s39
s_nop 0
buffer_load_dwordx4 v131, s[8:11], s40 offen lds
s_mul_i32 s39, s34, 7168
s_add_u32 s39, s39, 4096
s_mov_b32 m0, s39
s_nop 0
buffer_load_dwordx4 v132, s[8:11], s40 offen lds
s_mul_i32 s39, s34, 7168
s_add_u32 s39, s39, 5120
s_mov_b32 m0, s39
s_nop 0
buffer_load_dwordx4 v133, s[8:11], s40 offen lds
s_mul_i32 s39, s34, 7168
s_add_u32 s39, s39, 6144
s_mov_b32 m0, s39
s_nop 0
buffer_load_dwordx4 v134, s[8:11], s40 offen lds
s_cmp_eq_u32 s41, 1
s_cbranch_scc1 qkv_kernel_v1
ds_read_b64_tr_b16 v[136:137], v9 offset:28672
ds_read_b64_tr_b16 v[138:139], v9 offset:30464
ds_read_b64_tr_b16 v[140:141], v9 offset:28736
ds_read_b64_tr_b16 v[142:143], v9 offset:30528
ds_read_b64_tr_b16 v[144:145], v9 offset:28800
ds_read_b64_tr_b16 v[146:147], v9 offset:30592
ds_read_b64_tr_b16 v[148:149], v9 offset:28864
ds_read_b64_tr_b16 v[150:151], v9 offset:30656
ds_read_b64_tr_b16 v[152:153], v9 offset:28928
ds_read_b64_tr_b16 v[154:155], v9 offset:30720
ds_read_b64_tr_b16 v[156:157], v9 offset:28992
ds_read_b64_tr_b16 v[158:159], v9 offset:30784
ds_read_b64_tr_b16 v[160:161], v9 offset:29056
ds_read_b64_tr_b16 v[162:163], v9 offset:30848
ds_read_b64_tr_b16 v[164:165], v9 offset:35840
ds_read_b64_tr_b16 v[166:167], v9 offset:37632
ds_read_b64_tr_b16 v[168:169], v9 offset:35904
ds_read_b64_tr_b16 v[170:171], v9 offset:37696
ds_read_b64_tr_b16 v[172:173], v9 offset:35968
ds_read_b64_tr_b16 v[174:175], v9 offset:37760
ds_read_b64_tr_b16 v[176:177], v9 offset:36032
ds_read_b64_tr_b16 v[178:179], v9 offset:37824
ds_read_b64_tr_b16 v[180:181], v9 offset:36096
ds_read_b64_tr_b16 v[182:183], v9 offset:37888
ds_read_b64_tr_b16 v[184:185], v9 offset:36160
ds_read_b64_tr_b16 v[186:187], v9 offset:37952
ds_read_b64_tr_b16 v[188:189], v9 offset:36224
ds_read_b64_tr_b16 v[190:191], v9 offset:38016
s_waitcnt lgkmcnt(14)
v_mfma_f32_32x32x16_bf16 a[0:15], v[136:139], v[32:35], a[0:15]
v_mfma_f32_32x32x16_bf16 a[16:31], v[140:143], v[32:35], a[16:31]
v_mfma_f32_32x32x16_bf16 a[32:47], v[144:147], v[32:35], a[32:47]
v_mfma_f32_32x32x16_bf16 a[48:63], v[148:151], v[32:35], a[48:63]
v_mfma_f32_32x32x16_bf16 a[64:79], v[152:155], v[32:35], a[64:79]
v_mfma_f32_32x32x16_bf16 a[80:95], v[156:159], v[32:35], a[80:95]
v_mfma_f32_32x32x16_bf16 a[96:111], v[160:163], v[32:35], a[96:111]
ds_read_b64_tr_b16 v[136:137], v9 offset:43008
ds_read_b64_tr_b16 v[138:139], v9 offset:44800
ds_read_b64_tr_b16 v[140:141], v9 offset:43072
ds_read_b64_tr_b16 v[142:143], v9 offset:44864
ds_read_b64_tr_b16 v[144:145], v9 offset:43136
ds_read_b64_tr_b16 v[146:147], v9 offset:44928
ds_read_b64_tr_b16 v[148:149], v9 offset:43200
ds_read_b64_tr_b16 v[150:151], v9 offset:44992
ds_read_b64_tr_b16 v[152:153], v9 offset:43264
ds_read_b64_tr_b16 v[154:155], v9 offset:45056
ds_read_b64_tr_b16 v[156:157], v9 offset:43328
ds_read_b64_tr_b16 v[158:159], v9 offset:45120
ds_read_b64_tr_b16 v[160:161], v9 offset:43392
ds_read_b64_tr_b16 v[162:163], v9 offset:45184
s_waitcnt lgkmcnt(14)
v_mfma_f32_32x32x16_bf16 a[0:15], v[164:167], v[36:39], a[0:15]
v_mfma_f32_32x32x16_bf16 a[16:31], v[168:171], v[36:39], a[16:31]
v_mfma_f32_32x32x16_bf16 a[32:47], v[172:175], v[36:39], a[32:47]
v_mfma_f32_32x32x16_bf16 a[48:63], v[176:179], v[36:39], a[48:63]
v_mfma_f32_32x32x16_bf16 a[64:79], v[180:183], v[36:39], a[64:79]
v_mfma_f32_32x32x16_bf16 a[80:95], v[184:187], v[36:39], a[80:95]
v_mfma_f32_32x32x16_bf16 a[96:111], v[188:191], v[36:39], a[96:111]
ds_read_b64_tr_b16 v[164:165], v9 offset:50176
ds_read_b64_tr_b16 v[166:167], v9 offset:51968
ds_read_b64_tr_b16 v[168:169], v9 offset:50240
ds_read_b64_tr_b16 v[170:171], v9 offset:52032
ds_read_b64_tr_b16 v[172:173], v9 offset:50304
ds_read_b64_tr_b16 v[174:175], v9 offset:52096
ds_read_b64_tr_b16 v[176:177], v9 offset:50368
ds_read_b64_tr_b16 v[178:179], v9 offset:52160
ds_read_b64_tr_b16 v[180:181], v9 offset:50432
ds_read_b64_tr_b16 v[182:183], v9 offset:52224
ds_read_b64_tr_b16 v[184:185], v9 offset:50496
ds_read_b64_tr_b16 v[186:187], v9 offset:52288
ds_read_b64_tr_b16 v[188:189], v9 offset:50560
ds_read_b64_tr_b16 v[190:191], v9 offset:52352
s_waitcnt lgkmcnt(14)
v_mfma_f32_32x32x16_bf16 a[0:15], v[136:139], v[40:43], a[0:15]
v_mfma_f32_32x32x16_bf16 a[16:31], v[140:143], v[40:43], a[16:31]
v_mfma_f32_32x32x16_bf16 a[32:47], v[144:147], v[40:43], a[32:47]
v_mfma_f32_32x32x16_bf16 a[48:63], v[148:151], v[40:43], a[48:63]
v_mfma_f32_32x32x16_bf16 a[64:79], v[152:155], v[40:43], a[64:79]
v_mfma_f32_32x32x16_bf16 a[80:95], v[156:159], v[40:43], a[80:95]
v_mfma_f32_32x32x16_bf16 a[96:111], v[160:163], v[40:43], a[96:111]
s_waitcnt lgkmcnt(0)
v_mfma_f32_32x32x16_bf16 a[0:15], v[164:167], v[44:47], a[0:15]
v_mfma_f32_32x32x16_bf16 a[16:31], v[168:171], v[44:47], a[16:31]
v_mfma_f32_32x32x16_bf16 a[32:47], v[172:175], v[44:47], a[32:47]
v_mfma_f32_32x32x16_bf16 a[48:63], v[176:179], v[44:47], a[48:63]
v_mfma_f32_32x32x16_bf16 a[64:79], v[180:183], v[44:47], a[64:79]
v_mfma_f32_32x32x16_bf16 a[80:95], v[184:187], v[44:47], a[80:95]
v_mfma_f32_32x32x16_bf16 a[96:111], v[188:191], v[44:47], a[96:111]
s_branch qkv_kernel_j1
qkv_kernel_v1:
ds_read_b64_tr_b16 v[136:137], v9 offset:28672
ds_read_b64_tr_b16 v[138:139], v9 offset:30464
ds_read_b64_tr_b16 v[140:141], v9 offset:28736
ds_read_b64_tr_b16 v[142:143], v9 offset:30528
ds_read_b64_tr_b16 v[144:145], v9 offset:28800
ds_read_b64_tr_b16 v[146:147], v9 offset:30592
ds_read_b64_tr_b16 v[148:149], v9 offset:28864
ds_read_b64_tr_b16 v[150:151], v9 offset:30656
ds_read_b64_tr_b16 v[152:153], v9 offset:28928
ds_read_b64_tr_b16 v[154:155], v9 offset:30720
ds_read_b64_tr_b16 v[156:157], v9 offset:28992
ds_read_b64_tr_b16 v[158:159], v9 offset:30784
ds_read_b64_tr_b16 v[160:161], v9 offset:29056
ds_read_b64_tr_b16 v[162:163], v9 offset:30848
ds_read_b64_tr_b16 v[164:165], v9 offset:35840
ds_read_b64_tr_b16 v[166:167], v9 offset:37632
ds_read_b64_tr_b16 v[168:169], v9 offset:35904
ds_read_b64_tr_b16 v[170:171], v9 offset:37696
ds_read_b64_tr_b16 v[172:173], v9 offset:35968
ds_read_b64_tr_b16 v[174:175], v9 offset:37760
ds_read_b64_tr_b16 v[176:177], v9 offset:36032
ds_read_b64_tr_b16 v[178:179], v9 offset:37824
ds_read_b64_tr_b16 v[180:181], v9 offset:36096
ds_read_b64_tr_b16 v[182:183], v9 offset:37888
ds_read_b64_tr_b16 v[184:185], v9 offset:36160
ds_read_b64_tr_b16 v[186:187], v9 offset:37952
ds_read_b64_tr_b16 v[188:189], v9 offset:36224
ds_read_b64_tr_b16 v[190:191], v9 offset:38016
s_waitcnt lgkmcnt(14)
v_mfma_f32_32x32x16_bf16 a[0:15], v[32:35], v[136:139], a[0:15]
v_mfma_f32_32x32x16_bf16 a[16:31], v[32:35], v[140:143], a[16:31]
v_mfma_f32_32x32x16_bf16 a[32:47], v[32:35], v[144:147], a[32:47]
v_mfma_f32_32x32x16_bf16 a[48:63], v[32:35], v[148:151], a[48:63]
v_mfma_f32_32x32x16_bf16 a[64:79], v[32:35], v[152:155], a[64:79]
v_mfma_f32_32x32x16_bf16 a[80:95], v[32:35], v[156:159], a[80:95]
v_mfma_f32_32x32x16_bf16 a[96:111], v[32:35], v[160:163], a[96:111]
ds_read_b64_tr_b16 v[136:137], v9 offset:43008
ds_read_b64_tr_b16 v[138:139], v9 offset:44800
ds_read_b64_tr_b16 v[140:141], v9 offset:43072
ds_read_b64_tr_b16 v[142:143], v9 offset:44864
ds_read_b64_tr_b16 v[144:145], v9 offset:43136
ds_read_b64_tr_b16 v[146:147], v9 offset:44928
ds_read_b64_tr_b16 v[148:149], v9 offset:43200
ds_read_b64_tr_b16 v[150:151], v9 offset:44992
ds_read_b64_tr_b16 v[152:153], v9 offset:43264
ds_read_b64_tr_b16 v[154:155], v9 offset:45056
ds_read_b64_tr_b16 v[156:157], v9 offset:43328
ds_read_b64_tr_b16 v[158:159], v9 offset:45120
ds_read_b64_tr_b16 v[160:161], v9 offset:43392
ds_read_b64_tr_b16 v[162:163], v9 offset:45184
s_waitcnt lgkmcnt(14)
v_mfma_f32_32x32x16_bf16 a[0:15], v[36:39], v[164:167], a[0:15]
v_mfma_f32_32x32x16_bf16 a[16:31], v[36:39], v[168:171], a[16:31]
v_mfma_f32_32x32x16_bf16 a[32:47], v[36:39], v[172:175], a[32:47]
v_mfma_f32_32x32x16_bf16 a[48:63], v[36:39], v[176:179], a[48:63]
v_mfma_f32_32x32x16_bf16 a[64:79], v[36:39], v[180:183], a[64:79]
v_mfma_f32_32x32x16_bf16 a[80:95], v[36:39], v[184:187], a[80:95]
v_mfma_f32_32x32x16_bf16 a[96:111], v[36:39], v[188:191], a[96:111]
ds_read_b64_tr_b16 v[164:165], v9 offset:50176
ds_read_b64_tr_b16 v[166:167], v9 offset:51968
ds_read_b64_tr_b16 v[168:169], v9 offset:50240
ds_read_b64_tr_b16 v[170:171], v9 offset:52032
ds_read_b64_tr_b16 v[172:173], v9 offset:50304
ds_read_b64_tr_b16 v[174:175], v9 offset:52096
ds_read_b64_tr_b16 v[176:177], v9 offset:50368
ds_read_b64_tr_b16 v[178:179], v9 offset:52160
ds_read_b64_tr_b16 v[180:181], v9 offset:50432
ds_read_b64_tr_b16 v[182:183], v9 offset:52224
ds_read_b64_tr_b16 v[184:185], v9 offset:50496
ds_read_b64_tr_b16 v[186:187], v9 offset:52288
ds_read_b64_tr_b16 v[188:189], v9 offset:50560
ds_read_b64_tr_b16 v[190:191], v9 offset:52352
s_waitcnt lgkmcnt(14)
v_mfma_f32_32x32x16_bf16 a[0:15], v[40:43], v[136:139], a[0:15]
v_mfma_f32_32x32x16_bf16 a[16:31], v[40:43], v[140:143], a[16:31]
v_mfma_f32_32x32x16_bf16 a[32:47], v[40:43], v[144:147], a[32:47]
v_mfma_f32_32x32x16_bf16 a[48:63], v[40:43], v[148:151], a[48:63]
v_mfma_f32_32x32x16_bf16 a[64:79], v[40:43], v[152:155], a[64:79]
v_mfma_f32_32x32x16_bf16 a[80:95], v[40:43], v[156:159], a[80:95]
v_mfma_f32_32x32x16_bf16 a[96:111], v[40:43], v[160:163], a[96:111]
s_waitcnt lgkmcnt(0)
v_mfma_f32_32x32x16_bf16 a[0:15], v[44:47], v[164:167], a[0:15]
v_mfma_f32_32x32x16_bf16 a[16:31], v[44:47], v[168:171], a[16:31]
v_mfma_f32_32x32x16_bf16 a[32:47], v[44:47], v[172:175], a[32:47]
v_mfma_f32_32x32x16_bf16 a[48:63], v[44:47], v[176:179], a[48:63]
v_mfma_f32_32x32x16_bf16 a[64:79], v[44:47], v[180:183], a[64:79]
v_mfma_f32_32x32x16_bf16 a[80:95], v[44:47], v[184:187], a[80:95]
v_mfma_f32_32x32x16_bf16 a[96:111], v[44:47], v[188:191], a[96:111]
qkv_kernel_j1:
s_waitcnt vmcnt(0)
s_barrier
s_mov_b32 s40, 516096
s_mul_i32 s39, s34, 7168
s_add_u32 s39, s39, 28672
s_mov_b32 m0, s39
s_nop 0
buffer_load_dwordx4 v128, s[8:11], s40 offen lds
s_mul_i32 s39, s34, 7168
s_add_u32 s39, s39, 29696
s_mov_b32 m0, s39
s_nop 0
buffer_load_dwordx4 v129, s[8:11], s40 offen lds
s_mul_i32 s39, s34, 7168
s_add_u32 s39, s39, 30720
s_mov_b32 m0, s39
s_nop 0
buffer_load_dwordx4 v130, s[8:11], s40 offen lds
s_mul_i32 s39, s34, 7168
s_add_u32 s39, s39, 31744
s_mov_b32 m0, s39
s_nop 0
buffer_load_dwordx4 v131, s[8:11], s40 offen lds
s_mul_i32 s39, s34, 7168
s_add_u32 s39, s39, 32768
s_mov_b32 m0, s39
s_nop 0
buffer_load_dwordx4 v132, s[8:11], s40 offen lds
s_mul_i32 s39, s34, 7168
s_add_u32 s39, s39, 33792
s_mov_b32 m0, s39
s_nop 0
buffer_load_dwordx4 v133, s[8:11], s40 offen lds
s_mul_i32 s39, s34, 7168
s_add_u32 s39, s39, 34816
s_mov_b32 m0, s39
s_nop 0
buffer_load_dwordx4 v134, s[8:11], s40 offen lds
s_cmp_eq_u32 s41, 1
s_cbranch_scc1 qkv_kernel_v2
ds_read_b64_tr_b16 v[136:137], v9 offset:0
ds_read_b64_tr_b16 v[138:139], v9 offset:1792
ds_read_b64_tr_b16 v[140:141], v9 offset:64
ds_read_b64_tr_b16 v[142:143], v9 offset:1856
ds_read_b64_tr_b16 v[144:145], v9 offset:128
ds_read_b64_tr_b16 v[146:147], v9 offset:1920
ds_read_b64_tr_b16 v[148:149], v9 offset:192
ds_read_b64_tr_b16 v[150:151], v9 offset:1984
ds_read_b64_tr_b16 v[152:153], v9 offset:256
ds_read_b64_tr_b16 v[154:155], v9 offset:2048
ds_read_b64_tr_b16 v[156:157], v9 offset:320
ds_read_b64_tr_b16 v[158:159], v9 offset:2112
ds_read_b64_tr_b16 v[160:161], v9 offset:384
ds_read_b64_tr_b16 v[162:163], v9 offset:2176
ds_read_b64_tr_b16 v[164:165], v9 offset:7168
ds_read_b64_tr_b16 v[166:167], v9 offset:8960
ds_read_b64_tr_b16 v[168:169], v9 offset:7232
ds_read_b64_tr_b16 v[170:171], v9 offset:9024
ds_read_b64_tr_b16 v[172:173], v9 offset:7296
ds_read_b64_tr_b16 v[174:175], v9 offset:9088
ds_read_b64_tr_b16 v[176:177], v9 offset:7360
ds_read_b64_tr_b16 v[178:179], v9 offset:9152
ds_read_b64_tr_b16 v[180:181], v9 offset:7424
ds_read_b64_tr_b16 v[182:183], v9 offset:9216
ds_read_b64_tr_b16 v[184:185], v9 offset:7488
ds_read_b64_tr_b16 v[186:187], v9 offset:9280
ds_read_b64_tr_b16 v[188:189], v9 offset:7552
ds_read_b64_tr_b16 v[190:191], v9 offset:9344
s_waitcnt lgkmcnt(14)
v_mfma_f32_32x32x16_bf16 a[0:15], v[136:139], v[48:51], a[0:15]
v_mfma_f32_32x32x16_bf16 a[16:31], v[140:143], v[48:51], a[16:31]
v_mfma_f32_32x32x16_bf16 a[32:47], v[144:147], v[48:51], a[32:47]
v_mfma_f32_32x32x16_bf16 a[48:63], v[148:151], v[48:51], a[48:63]
v_mfma_f32_32x32x16_bf16 a[64:79], v[152:155], v[48:51], a[64:79]
v_mfma_f32_32x32x16_bf16 a[80:95], v[156:159], v[48:51], a[80:95]
v_mfma_f32_32x32x16_bf16 a[96:111], v[160:163], v[48:51], a[96:111]
ds_read_b64_tr_b16 v[136:137], v9 offset:14336
ds_read_b64_tr_b16 v[138:139], v9 offset:16128
ds_read_b64_tr_b16 v[140:141], v9 offset:14400
ds_read_b64_tr_b16 v[142:143], v9 offset:16192
ds_read_b64_tr_b16 v[144:145], v9 offset:14464
ds_read_b64_tr_b16 v[146:147], v9 offset:16256
ds_read_b64_tr_b16 v[148:149], v9 offset:14528
ds_read_b64_tr_b16 v[150:151], v9 offset:16320
ds_read_b64_tr_b16 v[152:153], v9 offset:14592
ds_read_b64_tr_b16 v[154:155], v9 offset:16384
ds_read_b64_tr_b16 v[156:157], v9 offset:14656
ds_read_b64_tr_b16 v[158:159], v9 offset:16448
ds_read_b64_tr_b16 v[160:161], v9 offset:14720
ds_read_b64_tr_b16 v[162:163], v9 offset:16512
s_waitcnt lgkmcnt(14)
v_mfma_f32_32x32x16_bf16 a[0:15], v[164:167], v[52:55], a[0:15]
v_mfma_f32_32x32x16_bf16 a[16:31], v[168:171], v[52:55], a[16:31]
v_mfma_f32_32x32x16_bf16 a[32:47], v[172:175], v[52:55], a[32:47]
v_mfma_f32_32x32x16_bf16 a[48:63], v[176:179], v[52:55], a[48:63]
v_mfma_f32_32x32x16_bf16 a[64:79], v[180:183], v[52:55], a[64:79]
v_mfma_f32_32x32x16_bf16 a[80:95], v[184:187], v[52:55], a[80:95]
v_mfma_f32_32x32x16_bf16 a[96:111], v[188:191], v[52:55], a[96:111]
ds_read_b64_tr_b16 v[164:165], v9 offset:21504
ds_read_b64_tr_b16 v[166:167], v9 offset:23296
ds_read_b64_tr_b16 v[168:169], v9 offset:21568
ds_read_b64_tr_b16 v[170:171], v9 offset:23360
ds_read_b64_tr_b16 v[172:173], v9 offset:21632
ds_read_b64_tr_b16 v[174:175], v9 offset:23424
ds_read_b64_tr_b16 v[176:177], v9 offset:21696
ds_read_b64_tr_b16 v[178:179], v9 offset:23488
ds_read_b64_tr_b16 v[180:181], v9 offset:21760
ds_read_b64_tr_b16 v[182:183], v9 offset:23552
ds_read_b64_tr_b16 v[184:185], v9 offset:21824
ds_read_b64_tr_b16 v[186:187], v9 offset:23616
ds_read_b64_tr_b16 v[188:189], v9 offset:21888
ds_read_b64_tr_b16 v[190:191], v9 offset:23680
s_waitcnt lgkmcnt(14)
v_mfma_f32_32x32x16_bf16 a[0:15], v[136:139], v[56:59], a[0:15]
v_mfma_f32_32x32x16_bf16 a[16:31], v[140:143], v[56:59], a[16:31]
v_mfma_f32_32x32x16_bf16 a[32:47], v[144:147], v[56:59], a[32:47]
v_mfma_f32_32x32x16_bf16 a[48:63], v[148:151], v[56:59], a[48:63]
v_mfma_f32_32x32x16_bf16 a[64:79], v[152:155], v[56:59], a[64:79]
v_mfma_f32_32x32x16_bf16 a[80:95], v[156:159], v[56:59], a[80:95]
v_mfma_f32_32x32x16_bf16 a[96:111], v[160:163], v[56:59], a[96:111]
s_waitcnt lgkmcnt(0)
v_mfma_f32_32x32x16_bf16 a[0:15], v[164:167], v[60:63], a[0:15]
v_mfma_f32_32x32x16_bf16 a[16:31], v[168:171], v[60:63], a[16:31]
v_mfma_f32_32x32x16_bf16 a[32:47], v[172:175], v[60:63], a[32:47]
v_mfma_f32_32x32x16_bf16 a[48:63], v[176:179], v[60:63], a[48:63]
v_mfma_f32_32x32x16_bf16 a[64:79], v[180:183], v[60:63], a[64:79]
v_mfma_f32_32x32x16_bf16 a[80:95], v[184:187], v[60:63], a[80:95]
v_mfma_f32_32x32x16_bf16 a[96:111], v[188:191], v[60:63], a[96:111]
s_branch qkv_kernel_j2
qkv_kernel_v2:
ds_read_b64_tr_b16 v[136:137], v9 offset:0
ds_read_b64_tr_b16 v[138:139], v9 offset:1792
ds_read_b64_tr_b16 v[140:141], v9 offset:64
ds_read_b64_tr_b16 v[142:143], v9 offset:1856
ds_read_b64_tr_b16 v[144:145], v9 offset:128
ds_read_b64_tr_b16 v[146:147], v9 offset:1920
ds_read_b64_tr_b16 v[148:149], v9 offset:192
ds_read_b64_tr_b16 v[150:151], v9 offset:1984
ds_read_b64_tr_b16 v[152:153], v9 offset:256
ds_read_b64_tr_b16 v[154:155], v9 offset:2048
ds_read_b64_tr_b16 v[156:157], v9 offset:320
ds_read_b64_tr_b16 v[158:159], v9 offset:2112
ds_read_b64_tr_b16 v[160:161], v9 offset:384
ds_read_b64_tr_b16 v[162:163], v9 offset:2176
ds_read_b64_tr_b16 v[164:165], v9 offset:7168
ds_read_b64_tr_b16 v[166:167], v9 offset:8960
ds_read_b64_tr_b16 v[168:169], v9 offset:7232
ds_read_b64_tr_b16 v[170:171], v9 offset:9024
ds_read_b64_tr_b16 v[172:173], v9 offset:7296
ds_read_b64_tr_b16 v[174:175], v9 offset:9088
ds_read_b64_tr_b16 v[176:177], v9 offset:7360
ds_read_b64_tr_b16 v[178:179], v9 offset:9152
ds_read_b64_tr_b16 v[180:181], v9 offset:7424
ds_read_b64_tr_b16 v[182:183], v9 offset:9216
ds_read_b64_tr_b16 v[184:185], v9 offset:7488
ds_read_b64_tr_b16 v[186:187], v9 offset:9280
ds_read_b64_tr_b16 v[188:189], v9 offset:7552
ds_read_b64_tr_b16 v[190:191], v9 offset:9344
s_waitcnt lgkmcnt(14)
v_mfma_f32_32x32x16_bf16 a[0:15], v[48:51], v[136:139], a[0:15]
v_mfma_f32_32x32x16_bf16 a[16:31], v[48:51], v[140:143], a[16:31]
v_mfma_f32_32x32x16_bf16 a[32:47], v[48:51], v[144:147], a[32:47]
v_mfma_f32_32x32x16_bf16 a[48:63], v[48:51], v[148:151], a[48:63]
v_mfma_f32_32x32x16_bf16 a[64:79], v[48:51], v[152:155], a[64:79]
v_mfma_f32_32x32x16_bf16 a[80:95], v[48:51], v[156:159], a[80:95]
v_mfma_f32_32x32x16_bf16 a[96:111], v[48:51], v[160:163], a[96:111]
ds_read_b64_tr_b16 v[136:137], v9 offset:14336
ds_read_b64_tr_b16 v[138:139], v9 offset:16128
ds_read_b64_tr_b16 v[140:141], v9 offset:14400
ds_read_b64_tr_b16 v[142:143], v9 offset:16192
ds_read_b64_tr_b16 v[144:145], v9 offset:14464
ds_read_b64_tr_b16 v[146:147], v9 offset:16256
ds_read_b64_tr_b16 v[148:149], v9 offset:14528
ds_read_b64_tr_b16 v[150:151], v9 offset:16320
ds_read_b64_tr_b16 v[152:153], v9 offset:14592
ds_read_b64_tr_b16 v[154:155], v9 offset:16384
ds_read_b64_tr_b16 v[156:157], v9 offset:14656
ds_read_b64_tr_b16 v[158:159], v9 offset:16448
ds_read_b64_tr_b16 v[160:161], v9 offset:14720
ds_read_b64_tr_b16 v[162:163], v9 offset:16512
s_waitcnt lgkmcnt(14)
v_mfma_f32_32x32x16_bf16 a[0:15], v[52:55], v[164:167], a[0:15]
v_mfma_f32_32x32x16_bf16 a[16:31], v[52:55], v[168:171], a[16:31]
v_mfma_f32_32x32x16_bf16 a[32:47], v[52:55], v[172:175], a[32:47]
v_mfma_f32_32x32x16_bf16 a[48:63], v[52:55], v[176:179], a[48:63]
v_mfma_f32_32x32x16_bf16 a[64:79], v[52:55], v[180:183], a[64:79]
v_mfma_f32_32x32x16_bf16 a[80:95], v[52:55], v[184:187], a[80:95]
v_mfma_f32_32x32x16_bf16 a[96:111], v[52:55], v[188:191], a[96:111]
ds_read_b64_tr_b16 v[164:165], v9 offset:21504
ds_read_b64_tr_b16 v[166:167], v9 offset:23296
ds_read_b64_tr_b16 v[168:169], v9 offset:21568
ds_read_b64_tr_b16 v[170:171], v9 offset:23360
ds_read_b64_tr_b16 v[172:173], v9 offset:21632
ds_read_b64_tr_b16 v[174:175], v9 offset:23424
ds_read_b64_tr_b16 v[176:177], v9 offset:21696
ds_read_b64_tr_b16 v[178:179], v9 offset:23488
ds_read_b64_tr_b16 v[180:181], v9 offset:21760
ds_read_b64_tr_b16 v[182:183], v9 offset:23552
ds_read_b64_tr_b16 v[184:185], v9 offset:21824
ds_read_b64_tr_b16 v[186:187], v9 offset:23616
ds_read_b64_tr_b16 v[188:189], v9 offset:21888
ds_read_b64_tr_b16 v[190:191], v9 offset:23680
s_waitcnt lgkmcnt(14)
v_mfma_f32_32x32x16_bf16 a[0:15], v[56:59], v[136:139], a[0:15]
v_mfma_f32_32x32x16_bf16 a[16:31], v[56:59], v[140:143], a[16:31]
v_mfma_f32_32x32x16_bf16 a[32:47], v[56:59], v[144:147], a[32:47]
v_mfma_f32_32x32x16_bf16 a[48:63], v[56:59], v[148:151], a[48:63]
v_mfma_f32_32x32x16_bf16 a[64:79], v[56:59], v[152:155], a[64:79]
v_mfma_f32_32x32x16_bf16 a[80:95], v[56:59], v[156:159], a[80:95]
v_mfma_f32_32x32x16_bf16 a[96:111], v[56:59], v[160:163], a[96:111]
s_waitcnt lgkmcnt(0)
v_mfma_f32_32x32x16_bf16 a[0:15], v[60:63], v[164:167], a[0:15]
v_mfma_f32_32x32x16_bf16 a[16:31], v[60:63], v[168:171], a[16:31]
v_mfma_f32_32x32x16_bf16 a[32:47], v[60:63], v[172:175], a[32:47]
v_mfma_f32_32x32x16_bf16 a[48:63], v[60:63], v[176:179], a[48:63]
v_mfma_f32_32x32x16_bf16 a[64:79], v[60:63], v[180:183], a[64:79]
v_mfma_f32_32x32x16_bf16 a[80:95], v[60:63], v[184:187], a[80:95]
v_mfma_f32_32x32x16_bf16 a[96:111], v[60:63], v[188:191], a[96:111]
qkv_kernel_j2:
s_waitcnt vmcnt(0)
s_barrier
s_mov_b32 s40, 688128
s_mul_i32 s39, s34, 7168
s_add_u32 s39, s39, 0
s_mov_b32 m0, s39
s_nop 0
buffer_load_dwordx4 v128, s[8:11], s40 offen lds
s_mul_i32 s39, s34, 7168
s_add_u32 s39, s39, 1024
s_mov_b32 m0, s39
s_nop 0
buffer_load_dwordx4 v129, s[8:11], s40 offen lds
s_mul_i32 s39, s34, 7168
s_add_u32 s39, s39, 2048
s_mov_b32 m0, s39
s_nop 0
buffer_load_dwordx4 v130, s[8:11], s40 offen lds
s_mul_i32 s39, s34, 7168
s_add_u32 s39, s39, 3072
s_mov_b32 m0, s39
s_nop 0
buffer_load_dwordx4 v131, s[8:11], s40 offen lds
s_mul_i32 s39, s34, 7168
s_add_u32 s39, s39, 4096
s_mov_b32 m0, s39
s_nop 0
buffer_load_dwordx4 v132, s[8:11], s40 offen lds
s_mul_i32 s39, s34, 7168
s_add_u32 s39, s39, 5120
s_mov_b32 m0, s39
s_nop 0
buffer_load_dwordx4 v133, s[8:11], s40 offen lds
s_mul_i32 s39, s34, 7168
s_add_u32 s39, s39, 6144
s_mov_b32 m0, s39
s_nop 0
buffer_load_dwordx4 v134, s[8:11], s40 offen lds
s_cmp_eq_u32 s41, 1
s_cbranch_scc1 qkv_kernel_v3
ds_read_b64_tr_b16 v[136:137], v9 offset:28672
ds_read_b64_tr_b16 v[138:139], v9 offset:30464
ds_read_b64_tr_b16 v[140:141], v9 offset:28736
ds_read_b64_tr_b16 v[142:143], v9 offset:30528
ds_read_b64_tr_b16 v[144:145], v9 offset:28800
ds_read_b64_tr_b16 v[146:147], v9 offset:30592
ds_read_b64_tr_b16 v[148:149], v9 offset:28864
ds_read_b64_tr_b16 v[150:151], v9 offset:30656
ds_read_b64_tr_b16 v[152:153], v9 offset:28928
ds_read_b64_tr_b16 v[154:155], v9 offset:30720
ds_read_b64_tr_b16 v[156:157], v9 offset:28992
ds_read_b64_tr_b16 v[158:159], v9 offset:30784
ds_read_b64_tr_b16 v[160:161], v9 offset:29056
ds_read_b64_tr_b16 v[162:163], v9 offset:30848
ds_read_b64_tr_b16 v[164:165], v9 offset:35840
ds_read_b64_tr_b16 v[166:167], v9 offset:37632
ds_read_b64_tr_b16 v[168:169], v9 offset:35904
ds_read_b64_tr_b16 v[170:171], v9 offset:37696
ds_read_b64_tr_b16 v[172:173], v9 offset:35968
ds_read_b64_tr_b16 v[174:175], v9 offset:37760
ds_read_b64_tr_b16 v[176:177], v9 offset:36032
ds_read_b64_tr_b16 v[178:179], v9 offset:37824
ds_read_b64_tr_b16 v[180:181], v9 offset:36096
ds_read_b64_tr_b16 v[182:183], v9 offset:37888
ds_read_b64_tr_b16 v[184:185], v9 offset:36160
ds_read_b64_tr_b16 v[186:187], v9 offset:37952
ds_read_b64_tr_b16 v[188:189], v9 offset:36224
ds_read_b64_tr_b16 v[190:191], v9 offset:38016
s_waitcnt lgkmcnt(14)
v_mfma_f32_32x32x16_bf16 a[0:15], v[136:139], v[64:67], a[0:15]
v_mfma_f32_32x32x16_bf16 a[16:31], v[140:143], v[64:67], a[16:31]
v_mfma_f32_32x32x16_bf16 a[32:47], v[144:147], v[64:67], a[32:47]
v_mfma_f32_32x32x16_bf16 a[48:63], v[148:151], v[64:67], a[48:63]
v_mfma_f32_32x32x16_bf16 a[64:79], v[152:155], v[64:67], a[64:79]
v_mfma_f32_32x32x16_bf16 a[80:95], v[156:159], v[64:67], a[80:95]
v_mfma_f32_32x32x16_bf16 a[96:111], v[160:163], v[64:67], a[96:111]
ds_read_b64_tr_b16 v[136:137], v9 offset:43008
ds_read_b64_tr_b16 v[138:139], v9 offset:44800
ds_read_b64_tr_b16 v[140:141], v9 offset:43072
ds_read_b64_tr_b16 v[142:143], v9 offset:44864
ds_read_b64_tr_b16 v[144:145], v9 offset:43136
ds_read_b64_tr_b16 v[146:147], v9 offset:44928
ds_read_b64_tr_b16 v[148:149], v9 offset:43200
ds_read_b64_tr_b16 v[150:151], v9 offset:44992
ds_read_b64_tr_b16 v[152:153], v9 offset:43264
ds_read_b64_tr_b16 v[154:155], v9 offset:45056
ds_read_b64_tr_b16 v[156:157], v9 offset:43328
ds_read_b64_tr_b16 v[158:159], v9 offset:45120
ds_read_b64_tr_b16 v[160:161], v9 offset:43392
ds_read_b64_tr_b16 v[162:163], v9 offset:45184
s_waitcnt lgkmcnt(14)
v_mfma_f32_32x32x16_bf16 a[0:15], v[164:167], v[68:71], a[0:15]
v_mfma_f32_32x32x16_bf16 a[16:31], v[168:171], v[68:71], a[16:31]
v_mfma_f32_32x32x16_bf16 a[32:47], v[172:175], v[68:71], a[32:47]
v_mfma_f32_32x32x16_bf16 a[48:63], v[176:179], v[68:71], a[48:63]
v_mfma_f32_32x32x16_bf16 a[64:79], v[180:183], v[68:71], a[64:79]
v_mfma_f32_32x32x16_bf16 a[80:95], v[184:187], v[68:71], a[80:95]
v_mfma_f32_32x32x16_bf16 a[96:111], v[188:191], v[68:71], a[96:111]
ds_read_b64_tr_b16 v[164:165], v9 offset:50176
ds_read_b64_tr_b16 v[166:167], v9 offset:51968
ds_read_b64_tr_b16 v[168:169], v9 offset:50240
ds_read_b64_tr_b16 v[170:171], v9 offset:52032
ds_read_b64_tr_b16 v[172:173], v9 offset:50304
ds_read_b64_tr_b16 v[174:175], v9 offset:52096
ds_read_b64_tr_b16 v[176:177], v9 offset:50368
ds_read_b64_tr_b16 v[178:179], v9 offset:52160
ds_read_b64_tr_b16 v[180:181], v9 offset:50432
ds_read_b64_tr_b16 v[182:183], v9 offset:52224
ds_read_b64_tr_b16 v[184:185], v9 offset:50496
ds_read_b64_tr_b16 v[186:187], v9 offset:52288
ds_read_b64_tr_b16 v[188:189], v9 offset:50560
ds_read_b64_tr_b16 v[190:191], v9 offset:52352
s_waitcnt lgkmcnt(14)
v_mfma_f32_32x32x16_bf16 a[0:15], v[136:139], v[72:75], a[0:15]
v_mfma_f32_32x32x16_bf16 a[16:31], v[140:143], v[72:75], a[16:31]
v_mfma_f32_32x32x16_bf16 a[32:47], v[144:147], v[72:75], a[32:47]
v_mfma_f32_32x32x16_bf16 a[48:63], v[148:151], v[72:75], a[48:63]
v_mfma_f32_32x32x16_bf16 a[64:79], v[152:155], v[72:75], a[64:79]
v_mfma_f32_32x32x16_bf16 a[80:95], v[156:159], v[72:75], a[80:95]
v_mfma_f32_32x32x16_bf16 a[96:111], v[160:163], v[72:75], a[96:111]
s_waitcnt lgkmcnt(0)
v_mfma_f32_32x32x16_bf16 a[0:15], v[164:167], v[76:79], a[0:15]
v_mfma_f32_32x32x16_bf16 a[16:31], v[168:171], v[76:79], a[16:31]
v_mfma_f32_32x32x16_bf16 a[32:47], v[172:175], v[76:79], a[32:47]
v_mfma_f32_32x32x16_bf16 a[48:63], v[176:179], v[76:79], a[48:63]
v_mfma_f32_32x32x16_bf16 a[64:79], v[180:183], v[76:79], a[64:79]
v_mfma_f32_32x32x16_bf16 a[80:95], v[184:187], v[76:79], a[80:95]
v_mfma_f32_32x32x16_bf16 a[96:111], v[188:191], v[76:79], a[96:111]
s_branch qkv_kernel_j3
qkv_kernel_v3:
ds_read_b64_tr_b16 v[136:137], v9 offset:28672
ds_read_b64_tr_b16 v[138:139], v9 offset:30464
ds_read_b64_tr_b16 v[140:141], v9 offset:28736
ds_read_b64_tr_b16 v[142:143], v9 offset:30528
ds_read_b64_tr_b16 v[144:145], v9 offset:28800
ds_read_b64_tr_b16 v[146:147], v9 offset:30592
ds_read_b64_tr_b16 v[148:149], v9 offset:28864
ds_read_b64_tr_b16 v[150:151], v9 offset:30656
ds_read_b64_tr_b16 v[152:153], v9 offset:28928
ds_read_b64_tr_b16 v[154:155], v9 offset:30720
ds_read_b64_tr_b16 v[156:157], v9 offset:28992
ds_read_b64_tr_b16 v[158:159], v9 offset:30784
ds_read_b64_tr_b16 v[160:161], v9 offset:29056
ds_read_b64_tr_b16 v[162:163], v9 offset:30848
ds_read_b64_tr_b16 v[164:165], v9 offset:35840
ds_read_b64_tr_b16 v[166:167], v9 offset:37632
ds_read_b64_tr_b16 v[168:169], v9 offset:35904
ds_read_b64_tr_b16 v[170:171], v9 offset:37696
ds_read_b64_tr_b16 v[172:173], v9 offset:35968
ds_read_b64_tr_b16 v[174:175], v9 offset:37760
ds_read_b64_tr_b16 v[176:177], v9 offset:36032
ds_read_b64_tr_b16 v[178:179], v9 offset:37824
ds_read_b64_tr_b16 v[180:181], v9 offset:36096
ds_read_b64_tr_b16 v[182:183], v9 offset:37888
ds_read_b64_tr_b16 v[184:185], v9 offset:36160
ds_read_b64_tr_b16 v[186:187], v9 offset:37952
ds_read_b64_tr_b16 v[188:189], v9 offset:36224
ds_read_b64_tr_b16 v[190:191], v9 offset:38016
s_waitcnt lgkmcnt(14)
v_mfma_f32_32x32x16_bf16 a[0:15], v[64:67], v[136:139], a[0:15]
v_mfma_f32_32x32x16_bf16 a[16:31], v[64:67], v[140:143], a[16:31]
v_mfma_f32_32x32x16_bf16 a[32:47], v[64:67], v[144:147], a[32:47]
v_mfma_f32_32x32x16_bf16 a[48:63], v[64:67], v[148:151], a[48:63]
v_mfma_f32_32x32x16_bf16 a[64:79], v[64:67], v[152:155], a[64:79]
v_mfma_f32_32x32x16_bf16 a[80:95], v[64:67], v[156:159], a[80:95]
v_mfma_f32_32x32x16_bf16 a[96:111], v[64:67], v[160:163], a[96:111]
ds_read_b64_tr_b16 v[136:137], v9 offset:43008
ds_read_b64_tr_b16 v[138:139], v9 offset:44800
ds_read_b64_tr_b16 v[140:141], v9 offset:43072
ds_read_b64_tr_b16 v[142:143], v9 offset:44864
ds_read_b64_tr_b16 v[144:145], v9 offset:43136
ds_read_b64_tr_b16 v[146:147], v9 offset:44928
ds_read_b64_tr_b16 v[148:149], v9 offset:43200
ds_read_b64_tr_b16 v[150:151], v9 offset:44992
ds_read_b64_tr_b16 v[152:153], v9 offset:43264
ds_read_b64_tr_b16 v[154:155], v9 offset:45056
ds_read_b64_tr_b16 v[156:157], v9 offset:43328
ds_read_b64_tr_b16 v[158:159], v9 offset:45120
ds_read_b64_tr_b16 v[160:161], v9 offset:43392
ds_read_b64_tr_b16 v[162:163], v9 offset:45184
s_waitcnt lgkmcnt(14)
v_mfma_f32_32x32x16_bf16 a[0:15], v[68:71], v[164:167], a[0:15]
v_mfma_f32_32x32x16_bf16 a[16:31], v[68:71], v[168:171], a[16:31]
v_mfma_f32_32x32x16_bf16 a[32:47], v[68:71], v[172:175], a[32:47]
v_mfma_f32_32x32x16_bf16 a[48:63], v[68:71], v[176:179], a[48:63]
v_mfma_f32_32x32x16_bf16 a[64:79], v[68:71], v[180:183], a[64:79]
v_mfma_f32_32x32x16_bf16 a[80:95], v[68:71], v[184:187], a[80:95]
v_mfma_f32_32x32x16_bf16 a[96:111], v[68:71], v[188:191], a[96:111]
ds_read_b64_tr_b16 v[164:165], v9 offset:50176
ds_read_b64_tr_b16 v[166:167], v9 offset:51968
ds_read_b64_tr_b16 v[168:169], v9 offset:50240
ds_read_b64_tr_b16 v[170:171], v9 offset:52032
ds_read_b64_tr_b16 v[172:173], v9 offset:50304
ds_read_b64_tr_b16 v[174:175], v9 offset:52096
ds_read_b64_tr_b16 v[176:177], v9 offset:50368
ds_read_b64_tr_b16 v[178:179], v9 offset:52160
ds_read_b64_tr_b16 v[180:181], v9 offset:50432
ds_read_b64_tr_b16 v[182:183], v9 offset:52224
ds_read_b64_tr_b16 v[184:185], v9 offset:50496
ds_read_b64_tr_b16 v[186:187], v9 offset:52288
ds_read_b64_tr_b16 v[188:189], v9 offset:50560
ds_read_b64_tr_b16 v[190:191], v9 offset:52352
s_waitcnt lgkmcnt(14)
v_mfma_f32_32x32x16_bf16 a[0:15], v[72:75], v[136:139], a[0:15]
v_mfma_f32_32x32x16_bf16 a[16:31], v[72:75], v[140:143], a[16:31]
v_mfma_f32_32x32x16_bf16 a[32:47], v[72:75], v[144:147], a[32:47]
v_mfma_f32_32x32x16_bf16 a[48:63], v[72:75], v[148:151], a[48:63]
v_mfma_f32_32x32x16_bf16 a[64:79], v[72:75], v[152:155], a[64:79]
v_mfma_f32_32x32x16_bf16 a[80:95], v[72:75], v[156:159], a[80:95]
v_mfma_f32_32x32x16_bf16 a[96:111], v[72:75], v[160:163], a[96:111]
s_waitcnt lgkmcnt(0)
v_mfma_f32_32x32x16_bf16 a[0:15], v[76:79], v[164:167], a[0:15]
v_mfma_f32_32x32x16_bf16 a[16:31], v[76:79], v[168:171], a[16:31]
v_mfma_f32_32x32x16_bf16 a[32:47], v[76:79], v[172:175], a[32:47]
v_mfma_f32_32x32x16_bf16 a[48:63], v[76:79], v[176:179], a[48:63]
v_mfma_f32_32x32x16_bf16 a[64:79], v[76:79], v[180:183], a[64:79]
v_mfma_f32_32x32x16_bf16 a[80:95], v[76:79], v[184:187], a[80:95]
v_mfma_f32_32x32x16_bf16 a[96:111], v[76:79], v[188:191], a[96:111]
qkv_kernel_j3:
s_waitcnt vmcnt(0)
s_barrier
s_mov_b32 s40, 860160
s_mul_i32 s39, s34, 7168
s_add_u32 s39, s39, 28672
s_mov_b32 m0, s39
s_nop 0
buffer_load_dwordx4 v128, s[8:11], s40 offen lds
s_mul_i32 s39, s34, 7168
s_add_u32 s39, s39, 29696
s_mov_b32 m0, s39
s_nop 0
buffer_load_dwordx4 v129, s[8:11], s40 offen lds
s_mul_i32 s39, s34, 7168
s_add_u32 s39, s39, 30720
s_mov_b32 m0, s39
s_nop 0
buffer_load_dwordx4 v130, s[8:11], s40 offen lds
s_mul_i32 s39, s34, 7168
s_add_u32 s39, s39, 31744
s_mov_b32 m0, s39
s_nop 0
buffer_load_dwordx4 v131, s[8:11], s40 offen lds
s_mul_i32 s39, s34, 7168
s_add_u32 s39, s39, 32768
s_mov_b32 m0, s39
s_nop 0
buffer_load_dwordx4 v132, s[8:11], s40 offen lds
s_mul_i32 s39, s34, 7168
s_add_u32 s39, s39, 33792
s_mov_b32 m0, s39
s_nop 0
buffer_load_dwordx4 v133, s[8:11], s40 offen lds
s_mul_i32 s39, s34, 7168
s_add_u32 s39, s39, 34816
s_mov_b32 m0, s39
s_nop 0
buffer_load_dwordx4 v134, s[8:11], s40 offen lds
s_cmp_eq_u32 s41, 1
s_cbranch_scc1 qkv_kernel_v4
ds_read_b64_tr_b16 v[136:137], v9 offset:0
ds_read_b64_tr_b16 v[138:139], v9 offset:1792
ds_read_b64_tr_b16 v[140:141], v9 offset:64
ds_read_b64_tr_b16 v[142:143], v9 offset:1856
ds_read_b64_tr_b16 v[144:145], v9 offset:128
ds_read_b64_tr_b16 v[146:147], v9 offset:1920
ds_read_b64_tr_b16 v[148:149], v9 offset:192
ds_read_b64_tr_b16 v[150:151], v9 offset:1984
ds_read_b64_tr_b16 v[152:153], v9 offset:256
ds_read_b64_tr_b16 v[154:155], v9 offset:2048
ds_read_b64_tr_b16 v[156:157], v9 offset:320
ds_read_b64_tr_b16 v[158:159], v9 offset:2112
ds_read_b64_tr_b16 v[160:161], v9 offset:384
ds_read_b64_tr_b16 v[162:163], v9 offset:2176
ds_read_b64_tr_b16 v[164:165], v9 offset:7168
ds_read_b64_tr_b16 v[166:167], v9 offset:8960
ds_read_b64_tr_b16 v[168:169], v9 offset:7232
ds_read_b64_tr_b16 v[170:171], v9 offset:9024
ds_read_b64_tr_b16 v[172:173], v9 offset:7296
ds_read_b64_tr_b16 v[174:175], v9 offset:9088
ds_read_b64_tr_b16 v[176:177], v9 offset:7360
ds_read_b64_tr_b16 v[178:179], v9 offset:9152
ds_read_b64_tr_b16 v[180:181], v9 offset:7424
ds_read_b64_tr_b16 v[182:183], v9 offset:9216
ds_read_b64_tr_b16 v[184:185], v9 offset:7488
ds_read_b64_tr_b16 v[186:187], v9 offset:9280
ds_read_b64_tr_b16 v[188:189], v9 offset:7552
ds_read_b64_tr_b16 v[190:191], v9 offset:9344
s_waitcnt lgkmcnt(14)
v_mfma_f32_32x32x16_bf16 a[0:15], v[136:139], v[80:83], a[0:15]
v_mfma_f32_32x32x16_bf16 a[16:31], v[140:143], v[80:83], a[16:31]
v_mfma_f32_32x32x16_bf16 a[32:47], v[144:147], v[80:83], a[32:47]
v_mfma_f32_32x32x16_bf16 a[48:63], v[148:151], v[80:83], a[48:63]
v_mfma_f32_32x32x16_bf16 a[64:79], v[152:155], v[80:83], a[64:79]
v_mfma_f32_32x32x16_bf16 a[80:95], v[156:159], v[80:83], a[80:95]
v_mfma_f32_32x32x16_bf16 a[96:111], v[160:163], v[80:83], a[96:111]
ds_read_b64_tr_b16 v[136:137], v9 offset:14336
ds_read_b64_tr_b16 v[138:139], v9 offset:16128
ds_read_b64_tr_b16 v[140:141], v9 offset:14400
ds_read_b64_tr_b16 v[142:143], v9 offset:16192
ds_read_b64_tr_b16 v[144:145], v9 offset:14464
ds_read_b64_tr_b16 v[146:147], v9 offset:16256
ds_read_b64_tr_b16 v[148:149], v9 offset:14528
ds_read_b64_tr_b16 v[150:151], v9 offset:16320
ds_read_b64_tr_b16 v[152:153], v9 offset:14592
ds_read_b64_tr_b16 v[154:155], v9 offset:16384
ds_read_b64_tr_b16 v[156:157], v9 offset:14656
ds_read_b64_tr_b16 v[158:159], v9 offset:16448
ds_read_b64_tr_b16 v[160:161], v9 offset:14720
ds_read_b64_tr_b16 v[162:163], v9 offset:16512
s_waitcnt lgkmcnt(14)
v_mfma_f32_32x32x16_bf16 a[0:15], v[164:167], v[84:87], a[0:15]
v_mfma_f32_32x32x16_bf16 a[16:31], v[168:171], v[84:87], a[16:31]
v_mfma_f32_32x32x16_bf16 a[32:47], v[172:175], v[84:87], a[32:47]
v_mfma_f32_32x32x16_bf16 a[48:63], v[176:179], v[84:87], a[48:63]
v_mfma_f32_32x32x16_bf16 a[64:79], v[180:183], v[84:87], a[64:79]
v_mfma_f32_32x32x16_bf16 a[80:95], v[184:187], v[84:87], a[80:95]
v_mfma_f32_32x32x16_bf16 a[96:111], v[188:191], v[84:87], a[96:111]
ds_read_b64_tr_b16 v[164:165], v9 offset:21504
ds_read_b64_tr_b16 v[166:167], v9 offset:23296
ds_read_b64_tr_b16 v[168:169], v9 offset:21568
ds_read_b64_tr_b16 v[170:171], v9 offset:23360
ds_read_b64_tr_b16 v[172:173], v9 offset:21632
ds_read_b64_tr_b16 v[174:175], v9 offset:23424
ds_read_b64_tr_b16 v[176:177], v9 offset:21696
ds_read_b64_tr_b16 v[178:179], v9 offset:23488
ds_read_b64_tr_b16 v[180:181], v9 offset:21760
ds_read_b64_tr_b16 v[182:183], v9 offset:23552
ds_read_b64_tr_b16 v[184:185], v9 offset:21824
ds_read_b64_tr_b16 v[186:187], v9 offset:23616
ds_read_b64_tr_b16 v[188:189], v9 offset:21888
ds_read_b64_tr_b16 v[190:191], v9 offset:23680
s_waitcnt lgkmcnt(14)
v_mfma_f32_32x32x16_bf16 a[0:15], v[136:139], v[88:91], a[0:15]
v_mfma_f32_32x32x16_bf16 a[16:31], v[140:143], v[88:91], a[16:31]
v_mfma_f32_32x32x16_bf16 a[32:47], v[144:147], v[88:91], a[32:47]
v_mfma_f32_32x32x16_bf16 a[48:63], v[148:151], v[88:91], a[48:63]
v_mfma_f32_32x32x16_bf16 a[64:79], v[152:155], v[88:91], a[64:79]
v_mfma_f32_32x32x16_bf16 a[80:95], v[156:159], v[88:91], a[80:95]
v_mfma_f32_32x32x16_bf16 a[96:111], v[160:163], v[88:91], a[96:111]
s_waitcnt lgkmcnt(0)
v_mfma_f32_32x32x16_bf16 a[0:15], v[164:167], v[92:95], a[0:15]
v_mfma_f32_32x32x16_bf16 a[16:31], v[168:171], v[92:95], a[16:31]
v_mfma_f32_32x32x16_bf16 a[32:47], v[172:175], v[92:95], a[32:47]
v_mfma_f32_32x32x16_bf16 a[48:63], v[176:179], v[92:95], a[48:63]
v_mfma_f32_32x32x16_bf16 a[64:79], v[180:183], v[92:95], a[64:79]
v_mfma_f32_32x32x16_bf16 a[80:95], v[184:187], v[92:95], a[80:95]
v_mfma_f32_32x32x16_bf16 a[96:111], v[188:191], v[92:95], a[96:111]
s_branch qkv_kernel_j4
qkv_kernel_v4:
ds_read_b64_tr_b16 v[136:137], v9 offset:0
ds_read_b64_tr_b16 v[138:139], v9 offset:1792
ds_read_b64_tr_b16 v[140:141], v9 offset:64
ds_read_b64_tr_b16 v[142:143], v9 offset:1856
ds_read_b64_tr_b16 v[144:145], v9 offset:128
ds_read_b64_tr_b16 v[146:147], v9 offset:1920
ds_read_b64_tr_b16 v[148:149], v9 offset:192
ds_read_b64_tr_b16 v[150:151], v9 offset:1984
ds_read_b64_tr_b16 v[152:153], v9 offset:256
ds_read_b64_tr_b16 v[154:155], v9 offset:2048
ds_read_b64_tr_b16 v[156:157], v9 offset:320
ds_read_b64_tr_b16 v[158:159], v9 offset:2112
ds_read_b64_tr_b16 v[160:161], v9 offset:384
ds_read_b64_tr_b16 v[162:163], v9 offset:2176
ds_read_b64_tr_b16 v[164:165], v9 offset:7168
ds_read_b64_tr_b16 v[166:167], v9 offset:8960
ds_read_b64_tr_b16 v[168:169], v9 offset:7232
ds_read_b64_tr_b16 v[170:171], v9 offset:9024
ds_read_b64_tr_b16 v[172:173], v9 offset:7296
ds_read_b64_tr_b16 v[174:175], v9 offset:9088
ds_read_b64_tr_b16 v[176:177], v9 offset:7360
ds_read_b64_tr_b16 v[178:179], v9 offset:9152
ds_read_b64_tr_b16 v[180:181], v9 offset:7424
ds_read_b64_tr_b16 v[182:183], v9 offset:9216
ds_read_b64_tr_b16 v[184:185], v9 offset:7488
ds_read_b64_tr_b16 v[186:187], v9 offset:9280
ds_read_b64_tr_b16 v[188:189], v9 offset:7552
ds_read_b64_tr_b16 v[190:191], v9 offset:9344
s_waitcnt lgkmcnt(14)
v_mfma_f32_32x32x16_bf16 a[0:15], v[80:83], v[136:139], a[0:15]
v_mfma_f32_32x32x16_bf16 a[16:31], v[80:83], v[140:143], a[16:31]
v_mfma_f32_32x32x16_bf16 a[32:47], v[80:83], v[144:147], a[32:47]
v_mfma_f32_32x32x16_bf16 a[48:63], v[80:83], v[148:151], a[48:63]
v_mfma_f32_32x32x16_bf16 a[64:79], v[80:83], v[152:155], a[64:79]
v_mfma_f32_32x32x16_bf16 a[80:95], v[80:83], v[156:159], a[80:95]
v_mfma_f32_32x32x16_bf16 a[96:111], v[80:83], v[160:163], a[96:111]
ds_read_b64_tr_b16 v[136:137], v9 offset:14336
ds_read_b64_tr_b16 v[138:139], v9 offset:16128
ds_read_b64_tr_b16 v[140:141], v9 offset:14400
ds_read_b64_tr_b16 v[142:143], v9 offset:16192
ds_read_b64_tr_b16 v[144:145], v9 offset:14464
ds_read_b64_tr_b16 v[146:147], v9 offset:16256
ds_read_b64_tr_b16 v[148:149], v9 offset:14528
ds_read_b64_tr_b16 v[150:151], v9 offset:16320
ds_read_b64_tr_b16 v[152:153], v9 offset:14592
ds_read_b64_tr_b16 v[154:155], v9 offset:16384
ds_read_b64_tr_b16 v[156:157], v9 offset:14656
ds_read_b64_tr_b16 v[158:159], v9 offset:16448
ds_read_b64_tr_b16 v[160:161], v9 offset:14720
ds_read_b64_tr_b16 v[162:163], v9 offset:16512
s_waitcnt lgkmcnt(14)
v_mfma_f32_32x32x16_bf16 a[0:15], v[84:87], v[164:167], a[0:15]
v_mfma_f32_32x32x16_bf16 a[16:31], v[84:87], v[168:171], a[16:31]
v_mfma_f32_32x32x16_bf16 a[32:47], v[84:87], v[172:175], a[32:47]
v_mfma_f32_32x32x16_bf16 a[48:63], v[84:87], v[176:179], a[48:63]
v_mfma_f32_32x32x16_bf16 a[64:79], v[84:87], v[180:183], a[64:79]
v_mfma_f32_32x32x16_bf16 a[80:95], v[84:87], v[184:187], a[80:95]
v_mfma_f32_32x32x16_bf16 a[96:111], v[84:87], v[188:191], a[96:111]
ds_read_b64_tr_b16 v[164:165], v9 offset:21504
ds_read_b64_tr_b16 v[166:167], v9 offset:23296
ds_read_b64_tr_b16 v[168:169], v9 offset:21568
ds_read_b64_tr_b16 v[170:171], v9 offset:23360
ds_read_b64_tr_b16 v[172:173], v9 offset:21632
ds_read_b64_tr_b16 v[174:175], v9 offset:23424
ds_read_b64_tr_b16 v[176:177], v9 offset:21696
ds_read_b64_tr_b16 v[178:179], v9 offset:23488
ds_read_b64_tr_b16 v[180:181], v9 offset:21760
ds_read_b64_tr_b16 v[182:183], v9 offset:23552
ds_read_b64_tr_b16 v[184:185], v9 offset:21824
ds_read_b64_tr_b16 v[186:187], v9 offset:23616
ds_read_b64_tr_b16 v[188:189], v9 offset:21888
ds_read_b64_tr_b16 v[190:191], v9 offset:23680
s_waitcnt lgkmcnt(14)
v_mfma_f32_32x32x16_bf16 a[0:15], v[88:91], v[136:139], a[0:15]
v_mfma_f32_32x32x16_bf16 a[16:31], v[88:91], v[140:143], a[16:31]
v_mfma_f32_32x32x16_bf16 a[32:47], v[88:91], v[144:147], a[32:47]
v_mfma_f32_32x32x16_bf16 a[48:63], v[88:91], v[148:151], a[48:63]
v_mfma_f32_32x32x16_bf16 a[64:79], v[88:91], v[152:155], a[64:79]
v_mfma_f32_32x32x16_bf16 a[80:95], v[88:91], v[156:159], a[80:95]
v_mfma_f32_32x32x16_bf16 a[96:111], v[88:91], v[160:163], a[96:111]
s_waitcnt lgkmcnt(0)
v_mfma_f32_32x32x16_bf16 a[0:15], v[92:95], v[164:167], a[0:15]
v_mfma_f32_32x32x16_bf16 a[16:31], v[92:95], v[168:171], a[16:31]
v_mfma_f32_32x32x16_bf16 a[32:47], v[92:95], v[172:175], a[32:47]
v_mfma_f32_32x32x16_bf16 a[48:63], v[92:95], v[176:179], a[48:63]
v_mfma_f32_32x32x16_bf16 a[64:79], v[92:95], v[180:183], a[64:79]
v_mfma_f32_32x32x16_bf16 a[80:95], v[92:95], v[184:187], a[80:95]
v_mfma_f32_32x32x16_bf16 a[96:111], v[92:95], v[188:191], a[96:111]
qkv_kernel_j4:
s_waitcnt vmcnt(0)
s_barrier
s_mov_b32 s40, 1032192
s_mul_i32 s39, s34, 7168
s_add_u32 s39, s39, 0
s_mov_b32 m0, s39
s_nop 0
buffer_load_dwordx4 v128, s[8:11], s40 offen lds
s_mul_i32 s39, s34, 7168
s_add_u32 s39, s39, 1024
s_mov_b32 m0, s39
s_nop 0
buffer_load_dwordx4 v129, s[8:11], s40 offen lds
s_mul_i32 s39, s34, 7168
s_add_u32 s39, s39, 2048
s_mov_b32 m0, s39
s_nop 0
buffer_load_dwordx4 v130, s[8:11], s40 offen lds
s_mul_i32 s39, s34, 7168
s_add_u32 s39, s39, 3072
s_mov_b32 m0, s39
s_nop 0
buffer_load_dwordx4 v131, s[8:11], s40 offen lds
s_mul_i32 s39, s34, 7168
s_add_u32 s39, s39, 4096
s_mov_b32 m0, s39
s_nop 0
buffer_load_dwordx4 v132, s[8:11], s40 offen lds
s_mul_i32 s39, s34, 7168
s_add_u32 s39, s39, 5120
s_mov_b32 m0, s39
s_nop 0
buffer_load_dwordx4 v133, s[8:11], s40 offen lds
s_mul_i32 s39, s34, 7168
s_add_u32 s39, s39, 6144
s_mov_b32 m0, s39
s_nop 0
buffer_load_dwordx4 v134, s[8:11], s40 offen lds
s_cmp_eq_u32 s41, 1
s_cbranch_scc1 qkv_kernel_v5
ds_read_b64_tr_b16 v[136:137], v9 offset:28672
ds_read_b64_tr_b16 v[138:139], v9 offset:30464
ds_read_b64_tr_b16 v[140:141], v9 offset:28736
ds_read_b64_tr_b16 v[142:143], v9 offset:30528
ds_read_b64_tr_b16 v[144:145], v9 offset:28800
ds_read_b64_tr_b16 v[146:147], v9 offset:30592
ds_read_b64_tr_b16 v[148:149], v9 offset:28864
ds_read_b64_tr_b16 v[150:151], v9 offset:30656
ds_read_b64_tr_b16 v[152:153], v9 offset:28928
ds_read_b64_tr_b16 v[154:155], v9 offset:30720
ds_read_b64_tr_b16 v[156:157], v9 offset:28992
ds_read_b64_tr_b16 v[158:159], v9 offset:30784
ds_read_b64_tr_b16 v[160:161], v9 offset:29056
ds_read_b64_tr_b16 v[162:163], v9 offset:30848
ds_read_b64_tr_b16 v[164:165], v9 offset:35840
ds_read_b64_tr_b16 v[166:167], v9 offset:37632
ds_read_b64_tr_b16 v[168:169], v9 offset:35904
ds_read_b64_tr_b16 v[170:171], v9 offset:37696
ds_read_b64_tr_b16 v[172:173], v9 offset:35968
ds_read_b64_tr_b16 v[174:175], v9 offset:37760
ds_read_b64_tr_b16 v[176:177], v9 offset:36032
ds_read_b64_tr_b16 v[178:179], v9 offset:37824
ds_read_b64_tr_b16 v[180:181], v9 offset:36096
ds_read_b64_tr_b16 v[182:183], v9 offset:37888
ds_read_b64_tr_b16 v[184:185], v9 offset:36160
ds_read_b64_tr_b16 v[186:187], v9 offset:37952
ds_read_b64_tr_b16 v[188:189], v9 offset:36224
ds_read_b64_tr_b16 v[190:191], v9 offset:38016
s_waitcnt lgkmcnt(14)
v_mfma_f32_32x32x16_bf16 a[0:15], v[136:139], v[96:99], a[0:15]
v_mfma_f32_32x32x16_bf16 a[16:31], v[140:143], v[96:99], a[16:31]
v_mfma_f32_32x32x16_bf16 a[32:47], v[144:147], v[96:99], a[32:47]
v_mfma_f32_32x32x16_bf16 a[48:63], v[148:151], v[96:99], a[48:63]
v_mfma_f32_32x32x16_bf16 a[64:79], v[152:155], v[96:99], a[64:79]
v_mfma_f32_32x32x16_bf16 a[80:95], v[156:159], v[96:99], a[80:95]
v_mfma_f32_32x32x16_bf16 a[96:111], v[160:163], v[96:99], a[96:111]
ds_read_b64_tr_b16 v[136:137], v9 offset:43008
ds_read_b64_tr_b16 v[138:139], v9 offset:44800
ds_read_b64_tr_b16 v[140:141], v9 offset:43072
ds_read_b64_tr_b16 v[142:143], v9 offset:44864
ds_read_b64_tr_b16 v[144:145], v9 offset:43136
ds_read_b64_tr_b16 v[146:147], v9 offset:44928
ds_read_b64_tr_b16 v[148:149], v9 offset:43200
ds_read_b64_tr_b16 v[150:151], v9 offset:44992
ds_read_b64_tr_b16 v[152:153], v9 offset:43264
ds_read_b64_tr_b16 v[154:155], v9 offset:45056
ds_read_b64_tr_b16 v[156:157], v9 offset:43328
ds_read_b64_tr_b16 v[158:159], v9 offset:45120
ds_read_b64_tr_b16 v[160:161], v9 offset:43392
ds_read_b64_tr_b16 v[162:163], v9 offset:45184
s_waitcnt lgkmcnt(14)
v_mfma_f32_32x32x16_bf16 a[0:15], v[164:167], v[100:103], a[0:15]
v_mfma_f32_32x32x16_bf16 a[16:31], v[168:171], v[100:103], a[16:31]
v_mfma_f32_32x32x16_bf16 a[32:47], v[172:175], v[100:103], a[32:47]
v_mfma_f32_32x32x16_bf16 a[48:63], v[176:179], v[100:103], a[48:63]
v_mfma_f32_32x32x16_bf16 a[64:79], v[180:183], v[100:103], a[64:79]
v_mfma_f32_32x32x16_bf16 a[80:95], v[184:187], v[100:103], a[80:95]
v_mfma_f32_32x32x16_bf16 a[96:111], v[188:191], v[100:103], a[96:111]
ds_read_b64_tr_b16 v[164:165], v9 offset:50176
ds_read_b64_tr_b16 v[166:167], v9 offset:51968
ds_read_b64_tr_b16 v[168:169], v9 offset:50240
ds_read_b64_tr_b16 v[170:171], v9 offset:52032
ds_read_b64_tr_b16 v[172:173], v9 offset:50304
ds_read_b64_tr_b16 v[174:175], v9 offset:52096
ds_read_b64_tr_b16 v[176:177], v9 offset:50368
ds_read_b64_tr_b16 v[178:179], v9 offset:52160
ds_read_b64_tr_b16 v[180:181], v9 offset:50432
ds_read_b64_tr_b16 v[182:183], v9 offset:52224
ds_read_b64_tr_b16 v[184:185], v9 offset:50496
ds_read_b64_tr_b16 v[186:187], v9 offset:52288
ds_read_b64_tr_b16 v[188:189], v9 offset:50560
ds_read_b64_tr_b16 v[190:191], v9 offset:52352
s_waitcnt lgkmcnt(14)
v_mfma_f32_32x32x16_bf16 a[0:15], v[136:139], v[104:107], a[0:15]
v_mfma_f32_32x32x16_bf16 a[16:31], v[140:143], v[104:107], a[16:31]
v_mfma_f32_32x32x16_bf16 a[32:47], v[144:147], v[104:107], a[32:47]
v_mfma_f32_32x32x16_bf16 a[48:63], v[148:151], v[104:107], a[48:63]
v_mfma_f32_32x32x16_bf16 a[64:79], v[152:155], v[104:107], a[64:79]
v_mfma_f32_32x32x16_bf16 a[80:95], v[156:159], v[104:107], a[80:95]
v_mfma_f32_32x32x16_bf16 a[96:111], v[160:163], v[104:107], a[96:111]
s_waitcnt lgkmcnt(0)
v_mfma_f32_32x32x16_bf16 a[0:15], v[164:167], v[108:111], a[0:15]
v_mfma_f32_32x32x16_bf16 a[16:31], v[168:171], v[108:111], a[16:31]
v_mfma_f32_32x32x16_bf16 a[32:47], v[172:175], v[108:111], a[32:47]
v_mfma_f32_32x32x16_bf16 a[48:63], v[176:179], v[108:111], a[48:63]
v_mfma_f32_32x32x16_bf16 a[64:79], v[180:183], v[108:111], a[64:79]
v_mfma_f32_32x32x16_bf16 a[80:95], v[184:187], v[108:111], a[80:95]
v_mfma_f32_32x32x16_bf16 a[96:111], v[188:191], v[108:111], a[96:111]
s_branch qkv_kernel_j5
qkv_kernel_v5:
ds_read_b64_tr_b16 v[136:137], v9 offset:28672
ds_read_b64_tr_b16 v[138:139], v9 offset:30464
ds_read_b64_tr_b16 v[140:141], v9 offset:28736
ds_read_b64_tr_b16 v[142:143], v9 offset:30528
ds_read_b64_tr_b16 v[144:145], v9 offset:28800
ds_read_b64_tr_b16 v[146:147], v9 offset:30592
ds_read_b64_tr_b16 v[148:149], v9 offset:28864
ds_read_b64_tr_b16 v[150:151], v9 offset:30656
ds_read_b64_tr_b16 v[152:153], v9 offset:28928
ds_read_b64_tr_b16 v[154:155], v9 offset:30720
ds_read_b64_tr_b16 v[156:157], v9 offset:28992
ds_read_b64_tr_b16 v[158:159], v9 offset:30784
ds_read_b64_tr_b16 v[160:161], v9 offset:29056
ds_read_b64_tr_b16 v[162:163], v9 offset:30848
ds_read_b64_tr_b16 v[164:165], v9 offset:35840
ds_read_b64_tr_b16 v[166:167], v9 offset:37632
ds_read_b64_tr_b16 v[168:169], v9 offset:35904
ds_read_b64_tr_b16 v[170:171], v9 offset:37696
ds_read_b64_tr_b16 v[172:173], v9 offset:35968
ds_read_b64_tr_b16 v[174:175], v9 offset:37760
ds_read_b64_tr_b16 v[176:177], v9 offset:36032
ds_read_b64_tr_b16 v[178:179], v9 offset:37824
ds_read_b64_tr_b16 v[180:181], v9 offset:36096
ds_read_b64_tr_b16 v[182:183], v9 offset:37888
ds_read_b64_tr_b16 v[184:185], v9 offset:36160
ds_read_b64_tr_b16 v[186:187], v9 offset:37952
ds_read_b64_tr_b16 v[188:189], v9 offset:36224
ds_read_b64_tr_b16 v[190:191], v9 offset:38016
s_waitcnt lgkmcnt(14)
v_mfma_f32_32x32x16_bf16 a[0:15], v[96:99], v[136:139], a[0:15]
v_mfma_f32_32x32x16_bf16 a[16:31], v[96:99], v[140:143], a[16:31]
v_mfma_f32_32x32x16_bf16 a[32:47], v[96:99], v[144:147], a[32:47]
v_mfma_f32_32x32x16_bf16 a[48:63], v[96:99], v[148:151], a[48:63]
v_mfma_f32_32x32x16_bf16 a[64:79], v[96:99], v[152:155], a[64:79]
v_mfma_f32_32x32x16_bf16 a[80:95], v[96:99], v[156:159], a[80:95]
v_mfma_f32_32x32x16_bf16 a[96:111], v[96:99], v[160:163], a[96:111]
ds_read_b64_tr_b16 v[136:137], v9 offset:43008
ds_read_b64_tr_b16 v[138:139], v9 offset:44800
ds_read_b64_tr_b16 v[140:141], v9 offset:43072
ds_read_b64_tr_b16 v[142:143], v9 offset:44864
ds_read_b64_tr_b16 v[144:145], v9 offset:43136
ds_read_b64_tr_b16 v[146:147], v9 offset:44928
ds_read_b64_tr_b16 v[148:149], v9 offset:43200
ds_read_b64_tr_b16 v[150:151], v9 offset:44992
ds_read_b64_tr_b16 v[152:153], v9 offset:43264
ds_read_b64_tr_b16 v[154:155], v9 offset:45056
ds_read_b64_tr_b16 v[156:157], v9 offset:43328
ds_read_b64_tr_b16 v[158:159], v9 offset:45120
ds_read_b64_tr_b16 v[160:161], v9 offset:43392
ds_read_b64_tr_b16 v[162:163], v9 offset:45184
s_waitcnt lgkmcnt(14)
v_mfma_f32_32x32x16_bf16 a[0:15], v[100:103], v[164:167], a[0:15]
v_mfma_f32_32x32x16_bf16 a[16:31], v[100:103], v[168:171], a[16:31]
v_mfma_f32_32x32x16_bf16 a[32:47], v[100:103], v[172:175], a[32:47]
v_mfma_f32_32x32x16_bf16 a[48:63], v[100:103], v[176:179], a[48:63]
v_mfma_f32_32x32x16_bf16 a[64:79], v[100:103], v[180:183], a[64:79]
v_mfma_f32_32x32x16_bf16 a[80:95], v[100:103], v[184:187], a[80:95]
v_mfma_f32_32x32x16_bf16 a[96:111], v[100:103], v[188:191], a[96:111]
ds_read_b64_tr_b16 v[164:165], v9 offset:50176
ds_read_b64_tr_b16 v[166:167], v9 offset:51968
ds_read_b64_tr_b16 v[168:169], v9 offset:50240
ds_read_b64_tr_b16 v[170:171], v9 offset:52032
ds_read_b64_tr_b16 v[172:173], v9 offset:50304
ds_read_b64_tr_b16 v[174:175], v9 offset:52096
ds_read_b64_tr_b16 v[176:177], v9 offset:50368
ds_read_b64_tr_b16 v[178:179], v9 offset:52160
ds_read_b64_tr_b16 v[180:181], v9 offset:50432
ds_read_b64_tr_b16 v[182:183], v9 offset:52224
ds_read_b64_tr_b16 v[184:185], v9 offset:50496
ds_read_b64_tr_b16 v[186:187], v9 offset:52288
ds_read_b64_tr_b16 v[188:189], v9 offset:50560
ds_read_b64_tr_b16 v[190:191], v9 offset:52352
s_waitcnt lgkmcnt(14)
v_mfma_f32_32x32x16_bf16 a[0:15], v[104:107], v[136:139], a[0:15]
v_mfma_f32_32x32x16_bf16 a[16:31], v[104:107], v[140:143], a[16:31]
v_mfma_f32_32x32x16_bf16 a[32:47], v[104:107], v[144:147], a[32:47]
v_mfma_f32_32x32x16_bf16 a[48:63], v[104:107], v[148:151], a[48:63]
v_mfma_f32_32x32x16_bf16 a[64:79], v[104:107], v[152:155], a[64:79]
v_mfma_f32_32x32x16_bf16 a[80:95], v[104:107], v[156:159], a[80:95]
v_mfma_f32_32x32x16_bf16 a[96:111], v[104:107], v[160:163], a[96:111]
s_waitcnt lgkmcnt(0)
v_mfma_f32_32x32x16_bf16 a[0:15], v[108:111], v[164:167], a[0:15]
v_mfma_f32_32x32x16_bf16 a[16:31], v[108:111], v[168:171], a[16:31]
v_mfma_f32_32x32x16_bf16 a[32:47], v[108:111], v[172:175], a[32:47]
v_mfma_f32_32x32x16_bf16 a[48:63], v[108:111], v[176:179], a[48:63]
v_mfma_f32_32x32x16_bf16 a[64:79], v[108:111], v[180:183], a[64:79]
v_mfma_f32_32x32x16_bf16 a[80:95], v[108:111], v[184:187], a[80:95]
v_mfma_f32_32x32x16_bf16 a[96:111], v[108:111], v[188:191], a[96:111]
qkv_kernel_j5:
s_waitcnt vmcnt(0)
s_barrier
s_cmp_eq_u32 s41, 1
s_cbranch_scc1 qkv_kernel_v6
ds_read_b64_tr_b16 v[136:137], v9 offset:0
ds_read_b64_tr_b16 v[138:139], v9 offset:1792
ds_read_b64_tr_b16 v[140:141], v9 offset:64
ds_read_b64_tr_b16 v[142:143], v9 offset:1856
ds_read_b64_tr_b16 v[144:145], v9 offset:128
ds_read_b64_tr_b16 v[146:147], v9 offset:1920
ds_read_b64_tr_b16 v[148:149], v9 offset:192
ds_read_b64_tr_b16 v[150:151], v9 offset:1984
ds_read_b64_tr_b16 v[152:153], v9 offset:256
ds_read_b64_tr_b16 v[154:155], v9 offset:2048
ds_read_b64_tr_b16 v[156:157], v9 offset:320
ds_read_b64_tr_b16 v[158:159], v9 offset:2112
ds_read_b64_tr_b16 v[160:161], v9 offset:384
ds_read_b64_tr_b16 v[162:163], v9 offset:2176
ds_read_b64_tr_b16 v[164:165], v9 offset:7168
ds_read_b64_tr_b16 v[166:167], v9 offset:8960
ds_read_b64_tr_b16 v[168:169], v9 offset:7232
ds_read_b64_tr_b16 v[170:171], v9 offset:9024
ds_read_b64_tr_b16 v[172:173], v9 offset:7296
ds_read_b64_tr_b16 v[174:175], v9 offset:9088
ds_read_b64_tr_b16 v[176:177], v9 offset:7360
ds_read_b64_tr_b16 v[178:179], v9 offset:9152
ds_read_b64_tr_b16 v[180:181], v9 offset:7424
ds_read_b64_tr_b16 v[182:183], v9 offset:9216
ds_read_b64_tr_b16 v[184:185], v9 offset:7488
ds_read_b64_tr_b16 v[186:187], v9 offset:9280
ds_read_b64_tr_b16 v[188:189], v9 offset:7552
ds_read_b64_tr_b16 v[190:191], v9 offset:9344
s_waitcnt lgkmcnt(14)
v_mfma_f32_32x32x16_bf16 a[0:15], v[136:139], v[112:115], a[0:15]
v_mfma_f32_32x32x16_bf16 a[16:31], v[140:143], v[112:115], a[16:31]
v_mfma_f32_32x32x16_bf16 a[32:47], v[144:147], v[112:115], a[32:47]
v_mfma_f32_32x32x16_bf16 a[48:63], v[148:151], v[112:115], a[48:63]
v_mfma_f32_32x32x16_bf16 a[64:79], v[152:155], v[112:115], a[64:79]
v_mfma_f32_32x32x16_bf16 a[80:95], v[156:159], v[112:115], a[80:95]
v_mfma_f32_32x32x16_bf16 a[96:111], v[160:163], v[112:115], a[96:111]
ds_read_b64_tr_b16 v[136:137], v9 offset:14336
ds_read_b64_tr_b16 v[138:139], v9 offset:16128
ds_read_b64_tr_b16 v[140:141], v9 offset:14400
ds_read_b64_tr_b16 v[142:143], v9 offset:16192
ds_read_b64_tr_b16 v[144:145], v9 offset:14464
ds_read_b64_tr_b16 v[146:147], v9 offset:16256
ds_read_b64_tr_b16 v[148:149], v9 offset:14528
ds_read_b64_tr_b16 v[150:151], v9 offset:16320
ds_read_b64_tr_b16 v[152:153], v9 offset:14592
ds_read_b64_tr_b16 v[154:155], v9 offset:16384
ds_read_b64_tr_b16 v[156:157], v9 offset:14656
ds_read_b64_tr_b16 v[158:159], v9 offset:16448
ds_read_b64_tr_b16 v[160:161], v9 offset:14720
ds_read_b64_tr_b16 v[162:163], v9 offset:16512
s_waitcnt lgkmcnt(14)
v_mfma_f32_32x32x16_bf16 a[0:15], v[164:167], v[116:119], a[0:15]
v_mfma_f32_32x32x16_bf16 a[16:31], v[168:171], v[116:119], a[16:31]
v_mfma_f32_32x32x16_bf16 a[32:47], v[172:175], v[116:119], a[32:47]
v_mfma_f32_32x32x16_bf16 a[48:63], v[176:179], v[116:119], a[48:63]
v_mfma_f32_32x32x16_bf16 a[64:79], v[180:183], v[116:119], a[64:79]
v_mfma_f32_32x32x16_bf16 a[80:95], v[184:187], v[116:119], a[80:95]
v_mfma_f32_32x32x16_bf16 a[96:111], v[188:191], v[116:119], a[96:111]
ds_read_b64_tr_b16 v[164:165], v9 offset:21504
ds_read_b64_tr_b16 v[166:167], v9 offset:23296
ds_read_b64_tr_b16 v[168:169], v9 offset:21568
ds_read_b64_tr_b16 v[170:171], v9 offset:23360
ds_read_b64_tr_b16 v[172:173], v9 offset:21632
ds_read_b64_tr_b16 v[174:175], v9 offset:23424
ds_read_b64_tr_b16 v[176:177], v9 offset:21696
ds_read_b64_tr_b16 v[178:179], v9 offset:23488
ds_read_b64_tr_b16 v[180:181], v9 offset:21760
ds_read_b64_tr_b16 v[182:183], v9 offset:23552
ds_read_b64_tr_b16 v[184:185], v9 offset:21824
ds_read_b64_tr_b16 v[186:187], v9 offset:23616
ds_read_b64_tr_b16 v[188:189], v9 offset:21888
ds_read_b64_tr_b16 v[190:191], v9 offset:23680
s_waitcnt lgkmcnt(14)
v_mfma_f32_32x32x16_bf16 a[0:15], v[136:139], v[120:123], a[0:15]
v_mfma_f32_32x32x16_bf16 a[16:31], v[140:143], v[120:123], a[16:31]
v_mfma_f32_32x32x16_bf16 a[32:47], v[144:147], v[120:123], a[32:47]
v_mfma_f32_32x32x16_bf16 a[48:63], v[148:151], v[120:123], a[48:63]
v_mfma_f32_32x32x16_bf16 a[64:79], v[152:155], v[120:123], a[64:79]
v_mfma_f32_32x32x16_bf16 a[80:95], v[156:159], v[120:123], a[80:95]
v_mfma_f32_32x32x16_bf16 a[96:111], v[160:163], v[120:123], a[96:111]
s_waitcnt lgkmcnt(0)
v_mfma_f32_32x32x16_bf16 a[0:15], v[164:167], v[124:127], a[0:15]
v_mfma_f32_32x32x16_bf16 a[16:31], v[168:171], v[124:127], a[16:31]
v_mfma_f32_32x32x16_bf16 a[32:47], v[172:175], v[124:127], a[32:47]
v_mfma_f32_32x32x16_bf16 a[48:63], v[176:179], v[124:127], a[48:63]
v_mfma_f32_32x32x16_bf16 a[64:79], v[180:183], v[124:127], a[64:79]
v_mfma_f32_32x32x16_bf16 a[80:95], v[184:187], v[124:127], a[80:95]
v_mfma_f32_32x32x16_bf16 a[96:111], v[188:191], v[124:127], a[96:111]
s_branch qkv_kernel_j6
qkv_kernel_v6:
ds_read_b64_tr_b16 v[136:137], v9 offset:0
ds_read_b64_tr_b16 v[138:139], v9 offset:1792
ds_read_b64_tr_b16 v[140:141], v9 offset:64
ds_read_b64_tr_b16 v[142:143], v9 offset:1856
ds_read_b64_tr_b16 v[144:145], v9 offset:128
ds_read_b64_tr_b16 v[146:147], v9 offset:1920
ds_read_b64_tr_b16 v[148:149], v9 offset:192
ds_read_b64_tr_b16 v[150:151], v9 offset:1984
ds_read_b64_tr_b16 v[152:153], v9 offset:256
ds_read_b64_tr_b16 v[154:155], v9 offset:2048
ds_read_b64_tr_b16 v[156:157], v9 offset:320
ds_read_b64_tr_b16 v[158:159], v9 offset:2112
ds_read_b64_tr_b16 v[160:161], v9 offset:384
ds_read_b64_tr_b16 v[162:163], v9 offset:2176
ds_read_b64_tr_b16 v[164:165], v9 offset:7168
ds_read_b64_tr_b16 v[166:167], v9 offset:8960
ds_read_b64_tr_b16 v[168:169], v9 offset:7232
ds_read_b64_tr_b16 v[170:171], v9 offset:9024
ds_read_b64_tr_b16 v[172:173], v9 offset:7296
ds_read_b64_tr_b16 v[174:175], v9 offset:9088
ds_read_b64_tr_b16 v[176:177], v9 offset:7360
ds_read_b64_tr_b16 v[178:179], v9 offset:9152
ds_read_b64_tr_b16 v[180:181], v9 offset:7424
ds_read_b64_tr_b16 v[182:183], v9 offset:9216
ds_read_b64_tr_b16 v[184:185], v9 offset:7488
ds_read_b64_tr_b16 v[186:187], v9 offset:9280
ds_read_b64_tr_b16 v[188:189], v9 offset:7552
ds_read_b64_tr_b16 v[190:191], v9 offset:9344
s_waitcnt lgkmcnt(14)
v_mfma_f32_32x32x16_bf16 a[0:15], v[112:115], v[136:139], a[0:15]
v_mfma_f32_32x32x16_bf16 a[16:31], v[112:115], v[140:143], a[16:31]
v_mfma_f32_32x32x16_bf16 a[32:47], v[112:115], v[144:147], a[32:47]
v_mfma_f32_32x32x16_bf16 a[48:63], v[112:115], v[148:151], a[48:63]
v_mfma_f32_32x32x16_bf16 a[64:79], v[112:115], v[152:155], a[64:79]
v_mfma_f32_32x32x16_bf16 a[80:95], v[112:115], v[156:159], a[80:95]
v_mfma_f32_32x32x16_bf16 a[96:111], v[112:115], v[160:163], a[96:111]
ds_read_b64_tr_b16 v[136:137], v9 offset:14336
ds_read_b64_tr_b16 v[138:139], v9 offset:16128
ds_read_b64_tr_b16 v[140:141], v9 offset:14400
ds_read_b64_tr_b16 v[142:143], v9 offset:16192
ds_read_b64_tr_b16 v[144:145], v9 offset:14464
ds_read_b64_tr_b16 v[146:147], v9 offset:16256
ds_read_b64_tr_b16 v[148:149], v9 offset:14528
ds_read_b64_tr_b16 v[150:151], v9 offset:16320
ds_read_b64_tr_b16 v[152:153], v9 offset:14592
ds_read_b64_tr_b16 v[154:155], v9 offset:16384
ds_read_b64_tr_b16 v[156:157], v9 offset:14656
ds_read_b64_tr_b16 v[158:159], v9 offset:16448
ds_read_b64_tr_b16 v[160:161], v9 offset:14720
ds_read_b64_tr_b16 v[162:163], v9 offset:16512
s_waitcnt lgkmcnt(14)
v_mfma_f32_32x32x16_bf16 a[0:15], v[116:119], v[164:167], a[0:15]
v_mfma_f32_32x32x16_bf16 a[16:31], v[116:119], v[168:171], a[16:31]
v_mfma_f32_32x32x16_bf16 a[32:47], v[116:119], v[172:175], a[32:47]
v_mfma_f32_32x32x16_bf16 a[48:63], v[116:119], v[176:179], a[48:63]
v_mfma_f32_32x32x16_bf16 a[64:79], v[116:119], v[180:183], a[64:79]
v_mfma_f32_32x32x16_bf16 a[80:95], v[116:119], v[184:187], a[80:95]
v_mfma_f32_32x32x16_bf16 a[96:111], v[116:119], v[188:191], a[96:111]
ds_read_b64_tr_b16 v[164:165], v9 offset:21504
ds_read_b64_tr_b16 v[166:167], v9 offset:23296
ds_read_b64_tr_b16 v[168:169], v9 offset:21568
ds_read_b64_tr_b16 v[170:171], v9 offset:23360
ds_read_b64_tr_b16 v[172:173], v9 offset:21632
ds_read_b64_tr_b16 v[174:175], v9 offset:23424
ds_read_b64_tr_b16 v[176:177], v9 offset:21696
ds_read_b64_tr_b16 v[178:179], v9 offset:23488
ds_read_b64_tr_b16 v[180:181], v9 offset:21760
ds_read_b64_tr_b16 v[182:183], v9 offset:23552
ds_read_b64_tr_b16 v[184:185], v9 offset:21824
ds_read_b64_tr_b16 v[186:187], v9 offset:23616
ds_read_b64_tr_b16 v[188:189], v9 offset:21888
ds_read_b64_tr_b16 v[190:191], v9 offset:23680
s_waitcnt lgkmcnt(14)
v_mfma_f32_32x32x16_bf16 a[0:15], v[120:123], v[136:139], a[0:15]
v_mfma_f32_32x32x16_bf16 a[16:31], v[120:123], v[140:143], a[16:31]
v_mfma_f32_32x32x16_bf16 a[32:47], v[120:123], v[144:147], a[32:47]
v_mfma_f32_32x32x16_bf16 a[48:63], v[120:123], v[148:151], a[48:63]
v_mfma_f32_32x32x16_bf16 a[64:79], v[120:123], v[152:155], a[64:79]
v_mfma_f32_32x32x16_bf16 a[80:95], v[120:123], v[156:159], a[80:95]
v_mfma_f32_32x32x16_bf16 a[96:111], v[120:123], v[160:163], a[96:111]
s_waitcnt lgkmcnt(0)
v_mfma_f32_32x32x16_bf16 a[0:15], v[124:127], v[164:167], a[0:15]
v_mfma_f32_32x32x16_bf16 a[16:31], v[124:127], v[168:171], a[16:31]
v_mfma_f32_32x32x16_bf16 a[32:47], v[124:127], v[172:175], a[32:47]
v_mfma_f32_32x32x16_bf16 a[48:63], v[124:127], v[176:179], a[48:63]
v_mfma_f32_32x32x16_bf16 a[64:79], v[124:127], v[180:183], a[64:79]
v_mfma_f32_32x32x16_bf16 a[80:95], v[124:127], v[184:187], a[80:95]
v_mfma_f32_32x32x16_bf16 a[96:111], v[124:127], v[188:191], a[96:111]
qkv_kernel_j6:
s_nop 15
s_nop 7
v_accvgpr_read_b32 v16, a0
v_accvgpr_read_b32 v17, a1
v_accvgpr_read_b32 v18, a2
v_accvgpr_read_b32 v19, a3
v_accvgpr_read_b32 v20, a4
v_accvgpr_read_b32 v21, a5
v_accvgpr_read_b32 v22, a6
v_accvgpr_read_b32 v23, a7
v_accvgpr_read_b32 v24, a8
v_accvgpr_read_b32 v25, a9
v_accvgpr_read_b32 v26, a10
v_accvgpr_read_b32 v27, a11
v_accvgpr_read_b32 v28, a12
v_accvgpr_read_b32 v29, a13
v_accvgpr_read_b32 v30, a14
v_accvgpr_read_b32 v31, a15
v_accvgpr_read_b32 v32, a16
v_accvgpr_read_b32 v33, a17
v_accvgpr_read_b32 v34, a18
v_accvgpr_read_b32 v35, a19
v_accvgpr_read_b32 v36, a20
v_accvgpr_read_b32 v37, a21
v_accvgpr_read_b32 v38, a22
v_accvgpr_read_b32 v39, a23
v_accvgpr_read_b32 v40, a24
v_accvgpr_read_b32 v41, a25
v_accvgpr_read_b32 v42, a26
v_accvgpr_read_b32 v43, a27
v_accvgpr_read_b32 v44, a28
v_accvgpr_read_b32 v45, a29
v_accvgpr_read_b32 v46, a30
v_accvgpr_read_b32 v47, a31
v_accvgpr_read_b32 v48, a32
v_accvgpr_read_b32 v49, a33
v_accvgpr_read_b32 v50, a34
v_accvgpr_read_b32 v51, a35
v_accvgpr_read_b32 v52, a36
v_accvgpr_read_b32 v53, a37
v_accvgpr_read_b32 v54, a38
v_accvgpr_read_b32 v55, a39
v_accvgpr_read_b32 v56, a40
v_accvgpr_read_b32 v57, a41
v_accvgpr_read_b32 v58, a42
v_accvgpr_read_b32 v59, a43
v_accvgpr_read_b32 v60, a44
v_accvgpr_read_b32 v61, a45
v_accvgpr_read_b32 v62, a46
v_accvgpr_read_b32 v63, a47
v_accvgpr_read_b32 v64, a48
v_accvgpr_read_b32 v65, a49
v_accvgpr_read_b32 v66, a50
v_accvgpr_read_b32 v67, a51
v_accvgpr_read_b32 v68, a52
v_accvgpr_read_b32 v69, a53
v_accvgpr_read_b32 v70, a54
v_accvgpr_read_b32 v71, a55
v_accvgpr_read_b32 v72, a56
v_accvgpr_read_b32 v73, a57
v_accvgpr_read_b32 v74, a58
v_accvgpr_read_b32 v75, a59
v_accvgpr_read_b32 v76, a60
v_accvgpr_read_b32 v77, a61
v_accvgpr_read_b32 v78, a62
v_accvgpr_read_b32 v79, a63
v_accvgpr_read_b32 v80, a64
v_accvgpr_read_b32 v81, a65
v_accvgpr_read_b32 v82, a66
v_accvgpr_read_b32 v83, a67
v_accvgpr_read_b32 v84, a68
v_accvgpr_read_b32 v85, a69
v_accvgpr_read_b32 v86, a70
v_accvgpr_read_b32 v87, a71
v_accvgpr_read_b32 v88, a72
v_accvgpr_read_b32 v89, a73
v_accvgpr_read_b32 v90, a74
v_accvgpr_read_b32 v91, a75
v_accvgpr_read_b32 v92, a76
v_accvgpr_read_b32 v93, a77
v_accvgpr_read_b32 v94, a78
v_accvgpr_read_b32 v95, a79
v_accvgpr_read_b32 v96, a80
v_accvgpr_read_b32 v97, a81
v_accvgpr_read_b32 v98, a82
v_accvgpr_read_b32 v99, a83
v_accvgpr_read_b32 v100, a84
v_accvgpr_read_b32 v101, a85
v_accvgpr_read_b32 v102, a86
v_accvgpr_read_b32 v103, a87
v_accvgpr_read_b32 v104, a88
v_accvgpr_read_b32 v105, a89
v_accvgpr_read_b32 v106, a90
v_accvgpr_read_b32 v107, a91
v_accvgpr_read_b32 v108, a92
v_accvgpr_read_b32 v109, a93
v_accvgpr_read_b32 v110, a94
v_accvgpr_read_b32 v111, a95
v_accvgpr_read_b32 v112, a96
v_accvgpr_read_b32 v113, a97
v_accvgpr_read_b32 v114, a98
v_accvgpr_read_b32 v115, a99
v_accvgpr_read_b32 v116, a100
v_accvgpr_read_b32 v117, a101
v_accvgpr_read_b32 v118, a102
v_accvgpr_read_b32 v119, a103
v_accvgpr_read_b32 v120, a104
v_accvgpr_read_b32 v121, a105
v_accvgpr_read_b32 v122, a106
v_accvgpr_read_b32 v123, a107
v_accvgpr_read_b32 v124, a108
v_accvgpr_read_b32 v125, a109
v_accvgpr_read_b32 v126, a110
v_accvgpr_read_b32 v127, a111
s_and_b32 s42, s22, 1
s_lshl_b32 s42, s42, 3
s_lshl_b32 s43, s20, 4
s_add_u32 s42, s42, s43
s_lshl_b32 s42, s42, 6
s_add_u32 s42, s42, s35
s_lshl_b32 s42, s42, 11
s_cmp_eq_u32 s41, 1
s_cbranch_scc1 qkv_kernel_ev
s_cmp_ge_u32 s22, 2
s_cselect_b32 s43, 4194304, 0
s_cselect_b32 s44, 1.0, 1049335798
s_add_u32 s42, s42, s43
v_lshlrev_b32 v5, 4, v3
v_mul_f32 v16, s44, v16
v_mul_f32 v17, s44, v17
v_mul_f32 v18, s44, v18
v_mul_f32 v19, s44, v19
v_cvt_pk_bf16_f32 v16, v16, v17
v_cvt_pk_bf16_f32 v17, v18, v19
s_mov_b32 s45, 8
s_add_u32 s46, s42, 0
v_mad_i32_i24 v6, v4, s45, v5
buffer_store_dwordx2 v[16:17], v6, s[12:15], s46 offen
v_mul_f32 v20, s44, v20
v_mul_f32 v21, s44, v21
v_mul_f32 v22, s44, v22
v_mul_f32 v23, s44, v23
v_cvt_pk_bf16_f32 v20, v20, v21
v_cvt_pk_bf16_f32 v21, v22, v23
s_mov_b32 s45, 8
s_add_u32 s46, s42, 512
v_mad_i32_i24 v6, v4, s45, v5
buffer_store_dwordx2 v[20:21], v6, s[12:15], s46 offen
v_mul_f32 v24, s44, v24
v_mul_f32 v25, s44, v25
v_mul_f32 v26, s44, v26
v_mul_f32 v27, s44, v27
v_cvt_pk_bf16_f32 v24, v24, v25
v_cvt_pk_bf16_f32 v25, v26, v27
s_mov_b32 s45, 8
s_add_u32 s46, s42, 1024
v_mad_i32_i24 v6, v4, s45, v5
buffer_store_dwordx2 v[24:25], v6, s[12:15], s46 offen
v_mul_f32 v28, s44, v28
v_mul_f32 v29, s44, v29
v_mul_f32 v30, s44, v30
v_mul_f32 v31, s44, v31
v_cvt_pk_bf16_f32 v28, v28, v29
v_cvt_pk_bf16_f32 v29, v30, v31
s_mov_b32 s45, 129536
s_add_u32 s46, s42, 1536
v_mad_i32_i24 v6, v4, s45, v5
buffer_store_dwordx2 v[28:29], v6, s[12:15], s46 offen
v_mul_f32 v32, s44, v32
v_mul_f32 v33, s44, v33
v_mul_f32 v34, s44, v34
v_mul_f32 v35, s44, v35
v_cvt_pk_bf16_f32 v32, v32, v33
v_cvt_pk_bf16_f32 v33, v34, v35
s_mov_b32 s45, 504
s_add_u32 s46, s42, 131080
v_mad_i32_i24 v6, v4, s45, v5
buffer_store_dwordx2 v[32:33], v6, s[12:15], s46 offen
v_mul_f32 v36, s44, v36
v_mul_f32 v37, s44, v37
v_mul_f32 v38, s44, v38
v_mul_f32 v39, s44, v39
v_cvt_pk_bf16_f32 v36, v36, v37
v_cvt_pk_bf16_f32 v37, v38, v39
s_mov_b32 s45, 504
s_add_u32 s46, s42, 131592
v_mad_i32_i24 v6, v4, s45, v5
buffer_store_dwordx2 v[36:37], v6, s[12:15], s46 offen
v_mul_f32 v40, s44, v40
v_mul_f32 v41, s44, v41
v_mul_f32 v42, s44, v42
v_mul_f32 v43, s44, v43
v_cvt_pk_bf16_f32 v40, v40, v41
v_cvt_pk_bf16_f32 v41, v42, v43
s_mov_b32 s45, 504
s_add_u32 s46, s42, 132104
v_mad_i32_i24 v6, v4, s45, v5
buffer_store_dwordx2 v[40:41], v6, s[12:15], s46 offen
v_mul_f32 v44, s44, v44
v_mul_f32 v45, s44, v45
v_mul_f32 v46, s44, v46
v_mul_f32 v47, s44, v47
v_cvt_pk_bf16_f32 v44, v44, v45
v_cvt_pk_bf16_f32 v45, v46, v47
s_mov_b32 s45, 8
s_add_u32 s46, s42, 262144
v_mad_i32_i24 v6, v4, s45, v5
buffer_store_dwordx2 v[44:45], v6, s[12:15], s46 offen
v_mul_f32 v48, s44, v48
v_mul_f32 v49, s44, v49
v_mul_f32 v50, s44, v50
v_mul_f32 v51, s44, v51
v_cvt_pk_bf16_f32 v48, v48, v49
v_cvt_pk_bf16_f32 v49, v50, v51
s_mov_b32 s45, 8
s_add_u32 s46, s42, 262656
v_mad_i32_i24 v6, v4, s45, v5
buffer_store_dwordx2 v[48:49], v6, s[12:15], s46 offen
v_mul_f32 v52, s44, v52
v_mul_f32 v53, s44, v53
v_mul_f32 v54, s44, v54
v_mul_f32 v55, s44, v55
v_cvt_pk_bf16_f32 v52, v52, v53
v_cvt_pk_bf16_f32 v53, v54, v55
s_mov_b32 s45, 8
s_add_u32 s46, s42, 263168
v_mad_i32_i24 v6, v4, s45, v5
buffer_store_dwordx2 v[52:53], v6, s[12:15], s46 offen
v_mul_f32 v56, s44, v56
v_mul_f32 v57, s44, v57
v_mul_f32 v58, s44, v58
v_mul_f32 v59, s44, v59
v_cvt_pk_bf16_f32 v56, v56, v57
v_cvt_pk_bf16_f32 v57, v58, v59
s_mov_b32 s45, 129536
s_add_u32 s46, s42, 263680
v_mad_i32_i24 v6, v4, s45, v5
buffer_store_dwordx2 v[56:57], v6, s[12:15], s46 offen
v_mul_f32 v60, s44, v60
v_mul_f32 v61, s44, v61
v_mul_f32 v62, s44, v62
v_mul_f32 v63, s44, v63
v_cvt_pk_bf16_f32 v60, v60, v61
v_cvt_pk_bf16_f32 v61, v62, v63
s_mov_b32 s45, 504
s_add_u32 s46, s42, 393224
v_mad_i32_i24 v6, v4, s45, v5
buffer_store_dwordx2 v[60:61], v6, s[12:15], s46 offen
v_mul_f32 v64, s44, v64
v_mul_f32 v65, s44, v65
v_mul_f32 v66, s44, v66
v_mul_f32 v67, s44, v67
v_cvt_pk_bf16_f32 v64, v64, v65
v_cvt_pk_bf16_f32 v65, v66, v67
s_mov_b32 s45, 504
s_add_u32 s46, s42, 393736
v_mad_i32_i24 v6, v4, s45, v5
buffer_store_dwordx2 v[64:65], v6, s[12:15], s46 offen
v_mul_f32 v68, s44, v68
v_mul_f32 v69, s44, v69
v_mul_f32 v70, s44, v70
v_mul_f32 v71, s44, v71
v_cvt_pk_bf16_f32 v68, v68, v69
v_cvt_pk_bf16_f32 v69, v70, v71
s_mov_b32 s45, 504
s_add_u32 s46, s42, 394248
v_mad_i32_i24 v6, v4, s45, v5
buffer_store_dwordx2 v[68:69], v6, s[12:15], s46 offen
v_mul_f32 v72, s44, v72
v_mul_f32 v73, s44, v73
v_mul_f32 v74, s44, v74
v_mul_f32 v75, s44, v75
v_cvt_pk_bf16_f32 v72, v72, v73
v_cvt_pk_bf16_f32 v73, v74, v75
s_mov_b32 s45, 8
s_add_u32 s46, s42, 524288
v_mad_i32_i24 v6, v4, s45, v5
buffer_store_dwordx2 v[72:73], v6, s[12:15], s46 offen
v_mul_f32 v76, s44, v76
v_mul_f32 v77, s44, v77
v_mul_f32 v78, s44, v78
v_mul_f32 v79, s44, v79
v_cvt_pk_bf16_f32 v76, v76, v77
v_cvt_pk_bf16_f32 v77, v78, v79
s_mov_b32 s45, 8
s_add_u32 s46, s42, 524800
v_mad_i32_i24 v6, v4, s45, v5
buffer_store_dwordx2 v[76:77], v6, s[12:15], s46 offen
v_mul_f32 v80, s44, v80
v_mul_f32 v81, s44, v81
v_mul_f32 v82, s44, v82
v_mul_f32 v83, s44, v83
v_cvt_pk_bf16_f32 v80, v80, v81
v_cvt_pk_bf16_f32 v81, v82, v83
s_mov_b32 s45, 8
s_add_u32 s46, s42, 525312
v_mad_i32_i24 v6, v4, s45, v5
buffer_store_dwordx2 v[80:81], v6, s[12:15], s46 offen
v_mul_f32 v84, s44, v84
v_mul_f32 v85, s44, v85
v_mul_f32 v86, s44, v86
v_mul_f32 v87, s44, v87
v_cvt_pk_bf16_f32 v84, v84, v85
v_cvt_pk_bf16_f32 v85, v86, v87
s_mov_b32 s45, 129536
s_add_u32 s46, s42, 525824
v_mad_i32_i24 v6, v4, s45, v5
buffer_store_dwordx2 v[84:85], v6, s[12:15], s46 offen
v_mul_f32 v88, s44, v88
v_mul_f32 v89, s44, v89
v_mul_f32 v90, s44, v90
v_mul_f32 v91, s44, v91
v_cvt_pk_bf16_f32 v88, v88, v89
v_cvt_pk_bf16_f32 v89, v90, v91
s_mov_b32 s45, 504
s_add_u32 s46, s42, 655368
v_mad_i32_i24 v6, v4, s45, v5
buffer_store_dwordx2 v[88:89], v6, s[12:15], s46 offen
v_mul_f32 v92, s44, v92
v_mul_f32 v93, s44, v93
v_mul_f32 v94, s44, v94
v_mul_f32 v95, s44, v95
v_cvt_pk_bf16_f32 v92, v92, v93
v_cvt_pk_bf16_f32 v93, v94, v95
s_mov_b32 s45, 504
s_add_u32 s46, s42, 655880
v_mad_i32_i24 v6, v4, s45, v5
buffer_store_dwordx2 v[92:93], v6, s[12:15], s46 offen
v_mul_f32 v96, s44, v96
v_mul_f32 v97, s44, v97
v_mul_f32 v98, s44, v98
v_mul_f32 v99, s44, v99
v_cvt_pk_bf16_f32 v96, v96, v97
v_cvt_pk_bf16_f32 v97, v98, v99
s_mov_b32 s45, 504
s_add_u32 s46, s42, 656392
v_mad_i32_i24 v6, v4, s45, v5
buffer_store_dwordx2 v[96:97], v6, s[12:15], s46 offen
v_mul_f32 v100, s44, v100
v_mul_f32 v101, s44, v101
v_mul_f32 v102, s44, v102
v_mul_f32 v103, s44, v103
v_cvt_pk_bf16_f32 v100, v100, v101
v_cvt_pk_bf16_f32 v101, v102, v103
s_mov_b32 s45, 8
s_add_u32 s46, s42, 786432
v_mad_i32_i24 v6, v4, s45, v5
buffer_store_dwordx2 v[100:101], v6, s[12:15], s46 offen
v_mul_f32 v104, s44, v104
v_mul_f32 v105, s44, v105
v_mul_f32 v106, s44, v106
v_mul_f32 v107, s44, v107
v_cvt_pk_bf16_f32 v104, v104, v105
v_cvt_pk_bf16_f32 v105, v106, v107
s_mov_b32 s45, 8
s_add_u32 s46, s42, 786944
v_mad_i32_i24 v6, v4, s45, v5
buffer_store_dwordx2 v[104:105], v6, s[12:15], s46 offen
v_mul_f32 v108, s44, v108
v_mul_f32 v109, s44, v109
v_mul_f32 v110, s44, v110
v_mul_f32 v111, s44, v111
v_cvt_pk_bf16_f32 v108, v108, v109
v_cvt_pk_bf16_f32 v109, v110, v111
s_mov_b32 s45, 8
s_add_u32 s46, s42, 787456
v_mad_i32_i24 v6, v4, s45, v5
buffer_store_dwordx2 v[108:109], v6, s[12:15], s46 offen
v_mul_f32 v112, s44, v112
v_mul_f32 v113, s44, v113
v_mul_f32 v114, s44, v114
v_mul_f32 v115, s44, v115
v_cvt_pk_bf16_f32 v112, v112, v113
v_cvt_pk_bf16_f32 v113, v114, v115
s_mov_b32 s45, 129536
s_add_u32 s46, s42, 787968
v_mad_i32_i24 v6, v4, s45, v5
buffer_store_dwordx2 v[112:113], v6, s[12:15], s46 offen
v_mul_f32 v116, s44, v116
v_mul_f32 v117, s44, v117
v_mul_f32 v118, s44, v118
v_mul_f32 v119, s44, v119
v_cvt_pk_bf16_f32 v116, v116, v117
v_cvt_pk_bf16_f32 v117, v118, v119
s_mov_b32 s45, 504
s_add_u32 s46, s42, 917512
v_mad_i32_i24 v6, v4, s45, v5
buffer_store_dwordx2 v[116:117], v6, s[12:15], s46 offen
v_mul_f32 v120, s44, v120
v_mul_f32 v121, s44, v121
v_mul_f32 v122, s44, v122
v_mul_f32 v123, s44, v123
v_cvt_pk_bf16_f32 v120, v120, v121
v_cvt_pk_bf16_f32 v121, v122, v123
s_mov_b32 s45, 504
s_add_u32 s46, s42, 918024
v_mad_i32_i24 v6, v4, s45, v5
buffer_store_dwordx2 v[120:121], v6, s[12:15], s46 offen
v_mul_f32 v124, s44, v124
v_mul_f32 v125, s44, v125
v_mul_f32 v126, s44, v126
v_mul_f32 v127, s44, v127
v_cvt_pk_bf16_f32 v124, v124, v125
v_cvt_pk_bf16_f32 v125, v126, v127
s_mov_b32 s45, 504
s_add_u32 s46, s42, 918536
v_mad_i32_i24 v6, v4, s45, v5
buffer_store_dwordx2 v[124:125], v6, s[12:15], s46 offen
v_mov_b32 v10, 0
v_mov_b32 v11, 0
v_lshlrev_b32 v6, 17, v4
v_add_u32 v6, v6, v5
s_add_u32 s46, s42, 1544
buffer_store_dwordx2 v[10:11], v6, s[12:15], s46 offen
s_add_u32 s46, s42, 263688
buffer_store_dwordx2 v[10:11], v6, s[12:15], s46 offen
s_add_u32 s46, s42, 525832
buffer_store_dwordx2 v[10:11], v6, s[12:15], s46 offen
s_add_u32 s46, s42, 787976
buffer_store_dwordx2 v[10:11], v6, s[12:15], s46 offen
s_branch qkv_kernel_end
qkv_kernel_ev:
s_add_u32 s42, s42, 8388608
v_add_u32 v5, 0, v3
v_mul_u32_u24 v6, 2341, v5
v_lshrrev_b32 v6, 16, v6
v_mul_u32_u24 v7, 28, v6
v_sub_u32 v7, v5, v7
v_lshlrev_b32 v6, 17, v6
v_lshl_add_u32 v6, v7, 4, v6
v_lshl_add_u32 v6, v4, 9, v6
v_cvt_pk_bf16_f32 v16, v16, v17
v_cvt_pk_bf16_f32 v17, v18, v19
v_cvt_pk_bf16_f32 v18, v20, v21
v_cvt_pk_bf16_f32 v19, v22, v23
buffer_store_dwordx4 v[16:19], v6, s[12:15], s42 offen offset:0
v_cvt_pk_bf16_f32 v24, v24, v25
v_cvt_pk_bf16_f32 v25, v26, v27
v_cvt_pk_bf16_f32 v26, v28, v29
v_cvt_pk_bf16_f32 v27, v30, v31
buffer_store_dwordx4 v[24:27], v6, s[12:15], s42 offen offset:1024
v_add_u32 v5, 32, v3
v_mul_u32_u24 v6, 2341, v5
v_lshrrev_b32 v6, 16, v6
v_mul_u32_u24 v7, 28, v6
v_sub_u32 v7, v5, v7
v_lshlrev_b32 v6, 17, v6
v_lshl_add_u32 v6, v7, 4, v6
v_lshl_add_u32 v6, v4, 9, v6
v_cvt_pk_bf16_f32 v32, v32, v33
v_cvt_pk_bf16_f32 v33, v34, v35
v_cvt_pk_bf16_f32 v34, v36, v37
v_cvt_pk_bf16_f32 v35, v38, v39
buffer_store_dwordx4 v[32:35], v6, s[12:15], s42 offen offset:0
v_cvt_pk_bf16_f32 v40, v40, v41
v_cvt_pk_bf16_f32 v41, v42, v43
v_cvt_pk_bf16_f32 v42, v44, v45
v_cvt_pk_bf16_f32 v43, v46, v47
buffer_store_dwordx4 v[40:43], v6, s[12:15], s42 offen offset:1024
v_add_u32 v5, 64, v3
v_mul_u32_u24 v6, 2341, v5
v_lshrrev_b32 v6, 16, v6
v_mul_u32_u24 v7, 28, v6
v_sub_u32 v7, v5, v7
v_lshlrev_b32 v6, 17, v6
v_lshl_add_u32 v6, v7, 4, v6
v_lshl_add_u32 v6, v4, 9, v6
v_cvt_pk_bf16_f32 v48, v48, v49
v_cvt_pk_bf16_f32 v49, v50, v51
v_cvt_pk_bf16_f32 v50, v52, v53
v_cvt_pk_bf16_f32 v51, v54, v55
buffer_store_dwordx4 v[48:51], v6, s[12:15], s42 offen offset:0
v_cvt_pk_bf16_f32 v56, v56, v57
v_cvt_pk_bf16_f32 v57, v58, v59
v_cvt_pk_bf16_f32 v58, v60, v61
v_cvt_pk_bf16_f32 v59, v62, v63
buffer_store_dwordx4 v[56:59], v6, s[12:15], s42 offen offset:1024
v_add_u32 v5, 96, v3
v_mul_u32_u24 v6, 2341, v5
v_lshrrev_b32 v6, 16, v6
v_mul_u32_u24 v7, 28, v6
v_sub_u32 v7, v5, v7
v_lshlrev_b32 v6, 17, v6
v_lshl_add_u32 v6, v7, 4, v6
v_lshl_add_u32 v6, v4, 9, v6
v_cvt_pk_bf16_f32 v64, v64, v65
v_cvt_pk_bf16_f32 v65, v66, v67
v_cvt_pk_bf16_f32 v66, v68, v69
v_cvt_pk_bf16_f32 v67, v70, v71
buffer_store_dwordx4 v[64:67], v6, s[12:15], s42 offen offset:0
v_cvt_pk_bf16_f32 v72, v72, v73
v_cvt_pk_bf16_f32 v73, v74, v75
v_cvt_pk_bf16_f32 v74, v76, v77
v_cvt_pk_bf16_f32 v75, v78, v79
buffer_store_dwordx4 v[72:75], v6, s[12:15], s42 offen offset:1024
v_add_u32 v5, 128, v3
v_mul_u32_u24 v6, 2341, v5
v_lshrrev_b32 v6, 16, v6
v_mul_u32_u24 v7, 28, v6
v_sub_u32 v7, v5, v7
v_lshlrev_b32 v6, 17, v6
v_lshl_add_u32 v6, v7, 4, v6
v_lshl_add_u32 v6, v4, 9, v6
v_cvt_pk_bf16_f32 v80, v80, v81
v_cvt_pk_bf16_f32 v81, v82, v83
v_cvt_pk_bf16_f32 v82, v84, v85
v_cvt_pk_bf16_f32 v83, v86, v87
buffer_store_dwordx4 v[80:83], v6, s[12:15], s42 offen offset:0
v_cvt_pk_bf16_f32 v88, v88, v89
v_cvt_pk_bf16_f32 v89, v90, v91
v_cvt_pk_bf16_f32 v90, v92, v93
v_cvt_pk_bf16_f32 v91, v94, v95
buffer_store_dwordx4 v[88:91], v6, s[12:15], s42 offen offset:1024
v_add_u32 v5, 160, v3
v_mul_u32_u24 v6, 2341, v5
v_lshrrev_b32 v6, 16, v6
v_mul_u32_u24 v7, 28, v6
v_sub_u32 v7, v5, v7
v_lshlrev_b32 v6, 17, v6
v_lshl_add_u32 v6, v7, 4, v6
v_lshl_add_u32 v6, v4, 9, v6
v_cvt_pk_bf16_f32 v96, v96, v97
v_cvt_pk_bf16_f32 v97, v98, v99
v_cvt_pk_bf16_f32 v98, v100, v101
v_cvt_pk_bf16_f32 v99, v102, v103
buffer_store_dwordx4 v[96:99], v6, s[12:15], s42 offen offset:0
v_cvt_pk_bf16_f32 v104, v104, v105
v_cvt_pk_bf16_f32 v105, v106, v107
v_cvt_pk_bf16_f32 v106, v108, v109
v_cvt_pk_bf16_f32 v107, v110, v111
buffer_store_dwordx4 v[104:107], v6, s[12:15], s42 offen offset:1024
v_add_u32 v5, 192, v3
v_mul_u32_u24 v6, 2341, v5
v_lshrrev_b32 v6, 16, v6
v_mul_u32_u24 v7, 28, v6
v_sub_u32 v7, v5, v7
v_lshlrev_b32 v6, 17, v6
v_lshl_add_u32 v6, v7, 4, v6
v_lshl_add_u32 v6, v4, 9, v6
v_cvt_pk_bf16_f32 v112, v112, v113
v_cvt_pk_bf16_f32 v113, v114, v115
v_cvt_pk_bf16_f32 v114, v116, v117
v_cvt_pk_bf16_f32 v115, v118, v119
buffer_store_dwordx4 v[112:115], v6, s[12:15], s42 offen offset:0
v_cvt_pk_bf16_f32 v120, v120, v121
v_cvt_pk_bf16_f32 v121, v122, v123
v_cvt_pk_bf16_f32 v122, v124, v125
v_cvt_pk_bf16_f32 v123, v126, v127
buffer_store_dwordx4 v[120:123], v6, s[12:15], s42 offen offset:1024
v_and_b32 v5, 3, v1
v_cmp_eq_u32 vcc, 0, v5
v_mov_b32 v7, 0x3f803f80
s_nop 1
v_cndmask_b32 v8, 0, v7, vcc
v_mov_b32 v9, v8
v_mov_b32 v10, v8
v_mov_b32 v11, v8
v_lshrrev_b32 v6, 4, v1
v_lshlrev_b32 v6, 17, v6
v_bfe_u32 v7, v1, 3, 1
v_lshl_add_u32 v6, v7, 10, v6
v_bfe_u32 v7, v1, 2, 1
v_lshl_add_u32 v6, v7, 9, v6
v_add_u32 v5, 28, v5
v_lshl_add_u32 v6, v5, 4, v6
s_add_u32 s46, s42, 0
buffer_store_dwordx4 v[8:11], v6, s[12:15], s46 offen
s_add_u32 s46, s42, 524288
buffer_store_dwordx4 v[8:11], v6, s[12:15], s46 offen
qkv_kernel_end:
s_endpgm
.globl attn_kernel
.p2align 8
.type attn_kernel,@function
attn_kernel:
s_cmp_ge_u32 s2, 512
s_cbranch_scc1 attn_kernel_end
s_load_dwordx2 s[28:29], s[0:1], 64
s_and_b32 s20, s2, 31
s_lshr_b32 s21, s2, 5
v_and_b32 v1, 63, v0
v_lshrrev_b32 v2, 6, v0
s_nop 0
v_readfirstlane_b32 s34, v2
v_lshlrev_b32 v2, 4, v1
s_waitcnt lgkmcnt(0)
s_mov_b32 s12, s28
s_and_b32 s13, s29, 0xffff
s_mov_b32 s14, 16777216
s_mov_b32 s15, 0x00020000
s_lshl_b32 s22, s20, 17
s_lshl_b32 s23, s21, 2
s_add_u32 s23, s23, s34
s_lshl_b32 s24, s23, 11
s_add_u32 s24, s24, s22
buffer_load_dwordx4 v[8:11], v2, s[12:15], s24 offen
buffer_load_dwordx4 v[12:15], v2, s[12:15], s24 offen offset:1024
s_cmp_ge_u32 s34, 2
s_cselect_b32 s25, 4194304, 0
s_add_u32 s25, s25, 4194304
s_add_u32 s25, s25, s22
s_and_b32 s26, s34, 1
s_lshl_b32 s26, s26, 12
s_add_u32 s25, s25, s26
s_lshl_b32 s27, s34, 12
s_mov_b32 s30, 0
s_add_u32 s31, s30, s27
s_add_u32 s31, s31, 0
s_mov_b32 m0, s31
s_add_u32 s32, s25, 0
buffer_load_dwordx4 v2, s[12:15], s32 offen lds
s_add_u32 s31, s30, s27
s_add_u32 s31, s31, 1024
s_mov_b32 m0, s31
s_add_u32 s32, s25, 1024
buffer_load_dwordx4 v2, s[12:15], s32 offen lds
s_add_u32 s31, s30, s27
s_add_u32 s31, s31, 2048
s_mov_b32 m0, s31
s_add_u32 s32, s25, 2048
buffer_load_dwordx4 v2, s[12:15], s32 offen lds
s_add_u32 s31, s30, s27
s_add_u32 s31, s31, 3072
s_mov_b32 m0, s31
s_add_u32 s32, s25, 3072
buffer_load_dwordx4 v2, s[12:15], s32 offen lds
s_add_u32 s25, s25, 8192
v_mov_b32 v16, 0
v_mov_b32 v32, 0
v_mov_b32 v17, 0
v_mov_b32 v33, 0
v_mov_b32 v18, 0
v_mov_b32 v34, 0
v_mov_b32 v19, 0
v_mov_b32 v35, 0
v_mov_b32 v20, 0
v_mov_b32 v36, 0
v_mov_b32 v21, 0
v_mov_b32 v37, 0
v_mov_b32 v22, 0
v_mov_b32 v38, 0
v_mov_b32 v23, 0
v_mov_b32 v39, 0
v_mov_b32 v24, 0
v_mov_b32 v40, 0
v_mov_b32 v25, 0
v_mov_b32 v41, 0
v_mov_b32 v26, 0
v_mov_b32 v42, 0
v_mov_b32 v27, 0
v_mov_b32 v43, 0
v_mov_b32 v28, 0
v_mov_b32 v44, 0
v_mov_b32 v29, 0
v_mov_b32 v45, 0
v_mov_b32 v30, 0
v_mov_b32 v46, 0
v_mov_b32 v31, 0
v_mov_b32 v47, 0
s_mov_b32 s33, 0
s_mov_b32 s36, 1
attn_kernel_loop:
s_waitcnt vmcnt(0)
s_barrier
v_add_u32 v3, s30, v2
s_xor_b32 s30, s30, 16384
s_cmp_lt_u32 s33, 15
s_cbranch_scc0 attn_kernel_nod
s_add_u32 s31, s30, s27
s_add_u32 s31, s31, 0
s_mov_b32 m0, s31
s_add_u32 s32, s25, 0
buffer_load_dwordx4 v2, s[12:15], s32 offen lds
s_add_u32 s31, s30, s27
s_add_u32 s31, s31, 1024
s_mov_b32 m0, s31
s_add_u32 s32, s25, 1024
buffer_load_dwordx4 v2, s[12:15], s32 offen lds
s_add_u32 s31, s30, s27
s_add_u32 s31, s31, 2048
s_mov_b32 m0, s31
s_add_u32 s32, s25, 2048
buffer_load_dwordx4 v2, s[12:15], s32 offen lds
s_add_u32 s31, s30, s27
s_add_u32 s31, s31, 3072
s_mov_b32 m0, s31
s_add_u32 s32, s25, 3072
buffer_load_dwordx4 v2, s[12:15], s32 offen lds
s_add_u32 s25, s25, 8192
attn_kernel_nod:
ds_read_b128 v[64:67], v3 offset:0
ds_read_b128 v[68:71], v3 offset:1024
ds_read_b128 v[72:75], v3 offset:8192
ds_read_b128 v[76:79], v3 offset:9216
s_waitcnt lgkmcnt(2)
v_mfma_f32_32x32x16_bf16 v[48:63], v[64:67], v[8:11], v[16:31]
v_mfma_f32_32x32x16_bf16 v[48:63], v[68:71], v[12:15], v[48:63]
ds_read_b128 v[96:99], v3 offset:2048
ds_read_b128 v[100:103], v3 offset:3072
ds_read_b128 v[104:107], v3 offset:10240
ds_read_b128 v[108:111], v3 offset:11264
s_waitcnt lgkmcnt(2)
v_mfma_f32_32x32x16_bf16 v[80:95], v[96:99], v[8:11], v[16:31]
v_mfma_f32_32x32x16_bf16 v[80:95], v[100:103], v[12:15], v[80:95]
v_max3_f32 v4, v48, v49, v50
v_max3_f32 v4, v4, v51, v52
v_max3_f32 v4, v4, v53, v54
v_max3_f32 v4, v4, v55, v56
v_max3_f32 v4, v4, v57, v58
v_max3_f32 v4, v4, v59, v60
v_max3_f32 v4, v4, v61, v62
v_max_f32 v4, v4, v63
v_cmp_lt_f32 vcc, 8.0, v4
s_cmp_eq_u32 s36, 1
s_cbranch_scc1 attn_kernel_r0
s_cbranch_vccz attn_kernel_c0
attn_kernel_r0:
s_nop 15
v_mov_b32 v5, v4
s_nop 1
v_permlane32_swap_b32 v5, v4
s_nop 1
v_max_f32 v4, v4, v5
s_cmp_eq_u32 s36, 1
s_cbranch_scc1 attn_kernel_f0
v_max_f32 v4, 0, v4
v_sub_f32 v5, 0, v4
v_exp_f32 v5, v5
s_nop 0
v_mul_f32 v32, v32, v5
v_mul_f32 v33, v33, v5
v_mul_f32 v34, v34, v5
v_mul_f32 v35, v35, v5
v_mul_f32 v36, v36, v5
v_mul_f32 v37, v37, v5
v_mul_f32 v38, v38, v5
v_mul_f32 v39, v39, v5
v_mul_f32 v40, v40, v5
v_mul_f32 v41, v41, v5
v_mul_f32 v42, v42, v5
v_mul_f32 v43, v43, v5
v_mul_f32 v44, v44, v5
v_mul_f32 v45, v45, v5
v_mul_f32 v46, v46, v5
v_mul_f32 v47, v47, v5
attn_kernel_f0:
s_mov_b32 s36, 0
v_sub_f32 v16, v16, v4
v_sub_f32 v48, v48, v4
v_sub_f32 v80, v80, v4
v_sub_f32 v17, v17, v4
v_sub_f32 v49, v49, v4
v_sub_f32 v81, v81, v4
v_sub_f32 v18, v18, v4
v_sub_f32 v50, v50, v4
v_sub_f32 v82, v82, v4
v_sub_f32 v19, v19, v4
v_sub_f32 v51, v51, v4
v_sub_f32 v83, v83, v4
v_sub_f32 v20, v20, v4
v_sub_f32 v52, v52, v4
v_sub_f32 v84, v84, v4
v_sub_f32 v21, v21, v4
v_sub_f32 v53, v53, v4
v_sub_f32 v85, v85, v4
v_sub_f32 v22, v22, v4
v_sub_f32 v54, v54, v4
v_sub_f32 v86, v86, v4
v_sub_f32 v23, v23, v4
v_sub_f32 v55, v55, v4
v_sub_f32 v87, v87, v4
v_sub_f32 v24, v24, v4
v_sub_f32 v56, v56, v4
v_sub_f32 v88, v88, v4
v_sub_f32 v25, v25, v4
v_sub_f32 v57, v57, v4
v_sub_f32 v89, v89, v4
v_sub_f32 v26, v26, v4
v_sub_f32 v58, v58, v4
v_sub_f32 v90, v90, v4
v_sub_f32 v27, v27, v4
v_sub_f32 v59, v59, v4
v_sub_f32 v91, v91, v4
v_sub_f32 v28, v28, v4
v_sub_f32 v60, v60, v4
v_sub_f32 v92, v92, v4
v_sub_f32 v29, v29, v4
v_sub_f32 v61, v61, v4
v_sub_f32 v93, v93, v4
v_sub_f32 v30, v30, v4
v_sub_f32 v62, v62, v4
v_sub_f32 v94, v94, v4
v_sub_f32 v31, v31, v4
v_sub_f32 v63, v63, v4
v_sub_f32 v95, v95, v4
attn_kernel_c0:
v_exp_f32 v48, v48
v_exp_f32 v49, v49
v_exp_f32 v50, v50
v_exp_f32 v51, v51
v_exp_f32 v52, v52
v_exp_f32 v53, v53
v_exp_f32 v54, v54
v_exp_f32 v55, v55
v_exp_f32 v56, v56
v_exp_f32 v57, v57
v_exp_f32 v58, v58
v_exp_f32 v59, v59
v_exp_f32 v60, v60
v_exp_f32 v61, v61
v_exp_f32 v62, v62
v_exp_f32 v63, v63
s_nop 0
v_cvt_pk_bf16_f32 v48, v48, v49
v_cvt_pk_bf16_f32 v49, v50, v51
v_cvt_pk_bf16_f32 v50, v52, v53
v_cvt_pk_bf16_f32 v51, v54, v55
v_cvt_pk_bf16_f32 v52, v56, v57
v_cvt_pk_bf16_f32 v53, v58, v59
v_cvt_pk_bf16_f32 v54, v60, v61
v_cvt_pk_bf16_f32 v55, v62, v63
s_nop 1
v_mfma_f32_32x32x16_bf16 v[32:47], v[72:75], v[48:51], v[32:47]
v_mfma_f32_32x32x16_bf16 v[32:47], v[76:79], v[52:55], v[32:47]
ds_read_b128 v[64:67], v3 offset:4096
ds_read_b128 v[68:71], v3 offset:5120
ds_read_b128 v[72:75], v3 offset:12288
ds_read_b128 v[76:79], v3 offset:13312
s_waitcnt lgkmcnt(2)
v_mfma_f32_32x32x16_bf16 v[48:63], v[64:67], v[8:11], v[16:31]
v_mfma_f32_32x32x16_bf16 v[48:63], v[68:71], v[12:15], v[48:63]
v_max3_f32 v4, v80, v81, v82
v_max3_f32 v4, v4, v83, v84
v_max3_f32 v4, v4, v85, v86
v_max3_f32 v4, v4, v87, v88
v_max3_f32 v4, v4, v89, v90
v_max3_f32 v4, v4, v91, v92
v_max3_f32 v4, v4, v93, v94
v_max_f32 v4, v4, v95
v_cmp_lt_f32 vcc, 8.0, v4
s_cmp_eq_u32 s36, 1
s_cbranch_scc1 attn_kernel_r1
s_cbranch_vccz attn_kernel_c1
attn_kernel_r1:
s_nop 15
v_mov_b32 v5, v4
s_nop 1
v_permlane32_swap_b32 v5, v4
s_nop 1
v_max_f32 v4, v4, v5
s_cmp_eq_u32 s36, 1
s_cbranch_scc1 attn_kernel_f1
v_max_f32 v4, 0, v4
v_sub_f32 v5, 0, v4
v_exp_f32 v5, v5
s_nop 0
v_mul_f32 v32, v32, v5
v_mul_f32 v33, v33, v5
v_mul_f32 v34, v34, v5
v_mul_f32 v35, v35, v5
v_mul_f32 v36, v36, v5
v_mul_f32 v37, v37, v5
v_mul_f32 v38, v38, v5
v_mul_f32 v39, v39, v5
v_mul_f32 v40, v40, v5
v_mul_f32 v41, v41, v5
v_mul_f32 v42, v42, v5
v_mul_f32 v43, v43, v5
v_mul_f32 v44, v44, v5
v_mul_f32 v45, v45, v5
v_mul_f32 v46, v46, v5
v_mul_f32 v47, v47, v5
attn_kernel_f1:
s_mov_b32 s36, 0
v_sub_f32 v16, v16, v4
v_sub_f32 v80, v80, v4
v_sub_f32 v48, v48, v4
v_sub_f32 v17, v17, v4
v_sub_f32 v81, v81, v4
v_sub_f32 v49, v49, v4
v_sub_f32 v18, v18, v4
v_sub_f32 v82, v82, v4
v_sub_f32 v50, v50, v4
v_sub_f32 v19, v19, v4
v_sub_f32 v83, v83, v4
v_sub_f32 v51, v51, v4
v_sub_f32 v20, v20, v4
v_sub_f32 v84, v84, v4
v_sub_f32 v52, v52, v4
v_sub_f32 v21, v21, v4
v_sub_f32 v85, v85, v4
v_sub_f32 v53, v53, v4
v_sub_f32 v22, v22, v4
v_sub_f32 v86, v86, v4
v_sub_f32 v54, v54, v4
v_sub_f32 v23, v23, v4
v_sub_f32 v87, v87, v4
v_sub_f32 v55, v55, v4
v_sub_f32 v24, v24, v4
v_sub_f32 v88, v88, v4
v_sub_f32 v56, v56, v4
v_sub_f32 v25, v25, v4
v_sub_f32 v89, v89, v4
v_sub_f32 v57, v57, v4
v_sub_f32 v26, v26, v4
v_sub_f32 v90, v90, v4
v_sub_f32 v58, v58, v4
v_sub_f32 v27, v27, v4
v_sub_f32 v91, v91, v4
v_sub_f32 v59, v59, v4
v_sub_f32 v28, v28, v4
v_sub_f32 v92, v92, v4
v_sub_f32 v60, v60, v4
v_sub_f32 v29, v29, v4
v_sub_f32 v93, v93, v4
v_sub_f32 v61, v61, v4
v_sub_f32 v30, v30, v4
v_sub_f32 v94, v94, v4
v_sub_f32 v62, v62, v4
v_sub_f32 v31, v31, v4
v_sub_f32 v95, v95, v4
v_sub_f32 v63, v63, v4
attn_kernel_c1:
v_exp_f32 v80, v80
v_exp_f32 v81, v81
v_exp_f32 v82, v82
v_exp_f32 v83, v83
v_exp_f32 v84, v84
v_exp_f32 v85, v85
v_exp_f32 v86, v86
v_exp_f32 v87, v87
v_exp_f32 v88, v88
v_exp_f32 v89, v89
v_exp_f32 v90, v90
v_exp_f32 v91, v91
v_exp_f32 v92, v92
v_exp_f32 v93, v93
v_exp_f32 v94, v94
v_exp_f32 v95, v95
s_nop 0
v_cvt_pk_bf16_f32 v80, v80, v81
v_cvt_pk_bf16_f32 v81, v82, v83
v_cvt_pk_bf16_f32 v82, v84, v85
v_cvt_pk_bf16_f32 v83, v86, v87
v_cvt_pk_bf16_f32 v84, v88, v89
v_cvt_pk_bf16_f32 v85, v90, v91
v_cvt_pk_bf16_f32 v86, v92, v93
v_cvt_pk_bf16_f32 v87, v94, v95
s_nop 1
v_mfma_f32_32x32x16_bf16 v[32:47], v[104:107], v[80:83], v[32:47]
v_mfma_f32_32x32x16_bf16 v[32:47], v[108:111], v[84:87], v[32:47]
ds_read_b128 v[96:99], v3 offset:6144
ds_read_b128 v[100:103], v3 offset:7168
ds_read_b128 v[104:107], v3 offset:14336
ds_read_b128 v[108:111], v3 offset:15360
s_waitcnt lgkmcnt(2)
v_mfma_f32_32x32x16_bf16 v[80:95], v[96:99], v[8:11], v[16:31]
v_mfma_f32_32x32x16_bf16 v[80:95], v[100:103], v[12:15], v[80:95]
v_max3_f32 v4, v48, v49, v50
v_max3_f32 v4, v4, v51, v52
v_max3_f32 v4, v4, v53, v54
v_max3_f32 v4, v4, v55, v56
v_max3_f32 v4, v4, v57, v58
v_max3_f32 v4, v4, v59, v60
v_max3_f32 v4, v4, v61, v62
v_max_f32 v4, v4, v63
v_cmp_lt_f32 vcc, 8.0, v4
s_cmp_eq_u32 s36, 1
s_cbranch_scc1 attn_kernel_r2
s_cbranch_vccz attn_kernel_c2
attn_kernel_r2:
s_nop 15
v_mov_b32 v5, v4
s_nop 1
v_permlane32_swap_b32 v5, v4
s_nop 1
v_max_f32 v4, v4, v5
s_cmp_eq_u32 s36, 1
s_cbranch_scc1 attn_kernel_f2
v_max_f32 v4, 0, v4
v_sub_f32 v5, 0, v4
v_exp_f32 v5, v5
s_nop 0
v_mul_f32 v32, v32, v5
v_mul_f32 v33, v33, v5
v_mul_f32 v34, v34, v5
v_mul_f32 v35, v35, v5
v_mul_f32 v36, v36, v5
v_mul_f32 v37, v37, v5
v_mul_f32 v38, v38, v5
v_mul_f32 v39, v39, v5
v_mul_f32 v40, v40, v5
v_mul_f32 v41, v41, v5
v_mul_f32 v42, v42, v5
v_mul_f32 v43, v43, v5
v_mul_f32 v44, v44, v5
v_mul_f32 v45, v45, v5
v_mul_f32 v46, v46, v5
v_mul_f32 v47, v47, v5
attn_kernel_f2:
s_mov_b32 s36, 0
v_sub_f32 v16, v16, v4
v_sub_f32 v48, v48, v4
v_sub_f32 v80, v80, v4
v_sub_f32 v17, v17, v4
v_sub_f32 v49, v49, v4
v_sub_f32 v81, v81, v4
v_sub_f32 v18, v18, v4
v_sub_f32 v50, v50, v4
v_sub_f32 v82, v82, v4
v_sub_f32 v19, v19, v4
v_sub_f32 v51, v51, v4
v_sub_f32 v83, v83, v4
v_sub_f32 v20, v20, v4
v_sub_f32 v52, v52, v4
v_sub_f32 v84, v84, v4
v_sub_f32 v21, v21, v4
v_sub_f32 v53, v53, v4
v_sub_f32 v85, v85, v4
v_sub_f32 v22, v22, v4
v_sub_f32 v54, v54, v4
v_sub_f32 v86, v86, v4
v_sub_f32 v23, v23, v4
v_sub_f32 v55, v55, v4
v_sub_f32 v87, v87, v4
v_sub_f32 v24, v24, v4
v_sub_f32 v56, v56, v4
v_sub_f32 v88, v88, v4
v_sub_f32 v25, v25, v4
v_sub_f32 v57, v57, v4
v_sub_f32 v89, v89, v4
v_sub_f32 v26, v26, v4
v_sub_f32 v58, v58, v4
v_sub_f32 v90, v90, v4
v_sub_f32 v27, v27, v4
v_sub_f32 v59, v59, v4
v_sub_f32 v91, v91, v4
v_sub_f32 v28, v28, v4
v_sub_f32 v60, v60, v4
v_sub_f32 v92, v92, v4
v_sub_f32 v29, v29, v4
v_sub_f32 v61, v61, v4
v_sub_f32 v93, v93, v4
v_sub_f32 v30, v30, v4
v_sub_f32 v62, v62, v4
v_sub_f32 v94, v94, v4
v_sub_f32 v31, v31, v4
v_sub_f32 v63, v63, v4
v_sub_f32 v95, v95, v4
attn_kernel_c2:
v_exp_f32 v48, v48
v_exp_f32 v49, v49
v_exp_f32 v50, v50
v_exp_f32 v51, v51
v_exp_f32 v52, v52
v_exp_f32 v53, v53
v_exp_f32 v54, v54
v_exp_f32 v55, v55
v_exp_f32 v56, v56
v_exp_f32 v57, v57
v_exp_f32 v58, v58
v_exp_f32 v59, v59
v_exp_f32 v60, v60
v_exp_f32 v61, v61
v_exp_f32 v62, v62
v_exp_f32 v63, v63
s_nop 0
v_cvt_pk_bf16_f32 v48, v48, v49
v_cvt_pk_bf16_f32 v49, v50, v51
v_cvt_pk_bf16_f32 v50, v52, v53
v_cvt_pk_bf16_f32 v51, v54, v55
v_cvt_pk_bf16_f32 v52, v56, v57
v_cvt_pk_bf16_f32 v53, v58, v59
v_cvt_pk_bf16_f32 v54, v60, v61
v_cvt_pk_bf16_f32 v55, v62, v63
s_nop 1
v_mfma_f32_32x32x16_bf16 v[32:47], v[72:75], v[48:51], v[32:47]
v_mfma_f32_32x32x16_bf16 v[32:47], v[76:79], v[52:55], v[32:47]
s_nop 15
v_max3_f32 v4, v80, v81, v82
v_max3_f32 v4, v4, v83, v84
v_max3_f32 v4, v4, v85, v86
v_max3_f32 v4, v4, v87, v88
v_max3_f32 v4, v4, v89, v90
v_max3_f32 v4, v4, v91, v92
v_max3_f32 v4, v4, v93, v94
v_max_f32 v4, v4, v95
v_cmp_lt_f32 vcc, 8.0, v4
s_cmp_eq_u32 s36, 1
s_cbranch_scc1 attn_kernel_r3
s_cbranch_vccz attn_kernel_c3
attn_kernel_r3:
s_nop 15
v_mov_b32 v5, v4
s_nop 1
v_permlane32_swap_b32 v5, v4
s_nop 1
v_max_f32 v4, v4, v5
s_cmp_eq_u32 s36, 1
s_cbranch_scc1 attn_kernel_f3
v_max_f32 v4, 0, v4
v_sub_f32 v5, 0, v4
v_exp_f32 v5, v5
s_nop 0
v_mul_f32 v32, v32, v5
v_mul_f32 v33, v33, v5
v_mul_f32 v34, v34, v5
v_mul_f32 v35, v35, v5
v_mul_f32 v36, v36, v5
v_mul_f32 v37, v37, v5
v_mul_f32 v38, v38, v5
v_mul_f32 v39, v39, v5
v_mul_f32 v40, v40, v5
v_mul_f32 v41, v41, v5
v_mul_f32 v42, v42, v5
v_mul_f32 v43, v43, v5
v_mul_f32 v44, v44, v5
v_mul_f32 v45, v45, v5
v_mul_f32 v46, v46, v5
v_mul_f32 v47, v47, v5
attn_kernel_f3:
s_mov_b32 s36, 0
v_sub_f32 v16, v16, v4
v_sub_f32 v80, v80, v4
v_sub_f32 v17, v17, v4
v_sub_f32 v81, v81, v4
v_sub_f32 v18, v18, v4
v_sub_f32 v82, v82, v4
v_sub_f32 v19, v19, v4
v_sub_f32 v83, v83, v4
v_sub_f32 v20, v20, v4
v_sub_f32 v84, v84, v4
v_sub_f32 v21, v21, v4
v_sub_f32 v85, v85, v4
v_sub_f32 v22, v22, v4
v_sub_f32 v86, v86, v4
v_sub_f32 v23, v23, v4
v_sub_f32 v87, v87, v4
v_sub_f32 v24, v24, v4
v_sub_f32 v88, v88, v4
v_sub_f32 v25, v25, v4
v_sub_f32 v89, v89, v4
v_sub_f32 v26, v26, v4
v_sub_f32 v90, v90, v4
v_sub_f32 v27, v27, v4
v_sub_f32 v91, v91, v4
v_sub_f32 v28, v28, v4
v_sub_f32 v92, v92, v4
v_sub_f32 v29, v29, v4
v_sub_f32 v93, v93, v4
v_sub_f32 v30, v30, v4
v_sub_f32 v94, v94, v4
v_sub_f32 v31, v31, v4
v_sub_f32 v95, v95, v4
attn_kernel_c3:
v_exp_f32 v80, v80
v_exp_f32 v81, v81
v_exp_f32 v82, v82
v_exp_f32 v83, v83
v_exp_f32 v84, v84
v_exp_f32 v85, v85
v_exp_f32 v86, v86
v_exp_f32 v87, v87
v_exp_f32 v88, v88
v_exp_f32 v89, v89
v_exp_f32 v90, v90
v_exp_f32 v91, v91
v_exp_f32 v92, v92
v_exp_f32 v93, v93
v_exp_f32 v94, v94
v_exp_f32 v95, v95
s_nop 0
v_cvt_pk_bf16_f32 v80, v80, v81
v_cvt_pk_bf16_f32 v81, v82, v83
v_cvt_pk_bf16_f32 v82, v84, v85
v_cvt_pk_bf16_f32 v83, v86, v87
v_cvt_pk_bf16_f32 v84, v88, v89
v_cvt_pk_bf16_f32 v85, v90, v91
v_cvt_pk_bf16_f32 v86, v92, v93
v_cvt_pk_bf16_f32 v87, v94, v95
s_nop 1
v_mfma_f32_32x32x16_bf16 v[32:47], v[104:107], v[80:83], v[32:47]
v_mfma_f32_32x32x16_bf16 v[32:47], v[108:111], v[84:87], v[32:47]
s_add_u32 s33, s33, 1
s_cmp_lt_u32 s33, 16
s_cbranch_scc1 attn_kernel_loop
s_nop 15
v_mov_b32 v4, v44
v_mov_b32 v5, v44
s_nop 1
v_permlane32_swap_b32 v5, v4
s_nop 1
v_rcp_f32 v4, v4
s_nop 0
v_mul_f32 v32, v32, v4
v_mul_f32 v33, v33, v4
v_mul_f32 v34, v34, v4
v_mul_f32 v35, v35, v4
v_mul_f32 v36, v36, v4
v_mul_f32 v37, v37, v4
v_mul_f32 v38, v38, v4
v_mul_f32 v39, v39, v4
v_mul_f32 v40, v40, v4
v_mul_f32 v41, v41, v4
v_mul_f32 v42, v42, v4
v_mul_f32 v43, v43, v4
v_mul_f32 v44, v44, v4
v_mul_f32 v45, v45, v4
v_mul_f32 v46, v46, v4
v_mul_f32 v47, v47, v4
v_cvt_pk_bf16_f32 v32, v32, v33
v_cvt_pk_bf16_f32 v33, v34, v35
v_cvt_pk_bf16_f32 v34, v36, v37
v_cvt_pk_bf16_f32 v35, v38, v39
v_cvt_pk_bf16_f32 v36, v40, v41
v_cvt_pk_bf16_f32 v37, v42, v43
v_cvt_pk_bf16_f32 v38, v44, v45
v_cvt_pk_bf16_f32 v39, v46, v47
s_lshr_b32 s37, s20, 4
s_mul_i32 s37, s37, 1835008
s_and_b32 s38, s20, 15
s_mul_i32 s38, s38, 56
s_add_u32 s37, s37, s38
s_mul_i32 s38, s23, 28672
s_add_u32 s37, s37, s38
s_add_u32 s37, s37, 12582912
v_and_b32 v5, 31, v1
v_mul_u32_u24 v5, 896, v5
v_lshrrev_b32 v6, 5, v1
v_lshl_add_u32 v5, v6, 3, v5
buffer_store_dwordx2 v[32:33], v5, s[12:15], s37 offen offset:0
buffer_store_dwordx2 v[34:35], v5, s[12:15], s37 offen offset:16
buffer_store_dwordx2 v[36:37], v5, s[12:15], s37 offen offset:32
v_cmp_gt_u32 vcc, 32, v1
s_and_saveexec_b64 s[40:41], vcc
buffer_store_dwordx2 v[38:39], v5, s[12:15], s37 offen offset:48
attn_kernel_end:
s_endpgm
.globl oproj_kernel
.p2align 8
.type oproj_kernel,@function
oproj_kernel:
s_cmp_ge_u32 s2, 224
s_cbranch_scc1 oproj_kernel_end
s_cmp_ge_u32 s2, 112
s_cselect_b32 s20, 1, 0
s_mul_i32 s23, s20, 112
s_sub_u32 s23, s2, s23
s_and_b32 s21, s23, 15
s_lshr_b32 s22, s23, 4
s_mul_i32 s24, s20, 24
s_load_dwordx2 s[28:29], s[0:1], 64
s_load_dwordx2 s[30:31], s[0:1], 48
s_add_u32 s25, s24, 16
s_load_dwordx2 s[32:33], s[0:1], s25
v_and_b32 v1, 63, v0
v_lshrrev_b32 v2, 6, v0
s_nop 0
v_readfirstlane_b32 s34, v2
v_and_b32 v3, 31, v1
v_lshrrev_b32 v4, 5, v1
s_waitcnt lgkmcnt(0)
s_mul_i32 s25, s20, 1835008
s_add_u32 s25, s25, 12582912
s_add_u32 s26, s28, s25
s_addc_u32 s27, s29, 0
s_mov_b32 s4, s26
s_and_b32 s5, s27, 0xffff
s_mov_b32 s6, 1835008
s_mov_b32 s7, 0x00020000
s_mov_b32 s8, s32
s_and_b32 s9, s33, 0xffff
s_mov_b32 s10, 401408
s_mov_b32 s11, 0x00020000
s_mov_b32 s12, s28
s_and_b32 s13, s29, 0xffff
s_mov_b32 s14, 16777216
s_mov_b32 s15, 0x00020000
s_mov_b32 s16, s30
s_and_b32 s17, s31, 0xffff
s_mov_b32 s18, 3670016
s_mov_b32 s19, 0x00020000
s_lshl_b32 s35, s21, 2
s_add_u32 s35, s35, s34
s_lshl_b32 s36, s35, 5
v_add_u32 v5, s36, v3
v_mul_u32_u24 v5, 896, v5
v_lshl_add_u32 v5, v4, 4, v5
s_mul_i32 s37, s22, 128
s_lshl_b32 s38, s34, 6
s_mul_i32 s39, s34, 128
s_add_u32 s39, s39, 0
v_add_u32 v6, s39, v1
v_lshrrev_b32 v7, 3, v6
v_mul_u32_u24 v8, 8, v7
v_sub_u32 v8, v6, v8
v_mul_u32_u24 v7, 896, v7
v_lshl_add_u32 v7, v8, 4, v7
v_add_u32 v128, s37, v7
s_mul_i32 s39, s34, 128
s_add_u32 s39, s39, 64
v_add_u32 v6, s39, v1
v_lshrrev_b32 v7, 3, v6
v_mul_u32_u24 v8, 8, v7
v_sub_u32 v8, v6, v8
v_mul_u32_u24 v7, 896, v7
v_lshl_add_u32 v7, v8, 4, v7
v_add_u32 v129, s37, v7
s_mov_b32 s40, 0
s_mul_i32 s39, s34, 2048
s_add_u32 s39, s39, 0
s_mov_b32 m0, s39
s_nop 0
buffer_load_dwordx4 v128, s[8:11], s40 offen lds
s_mul_i32 s39, s34, 2048
s_add_u32 s39, s39, 1024
s_mov_b32 m0, s39
s_nop 0
buffer_load_dwordx4 v129, s[8:11], s40 offen lds
buffer_load_dwordx4 v[16:19], v5, s[4:7], 0 offen offset:0
buffer_load_dwordx4 v[20:23], v5, s[4:7], 0 offen offset:32
buffer_load_dwordx4 v[24:27], v5, s[4:7], 0 offen offset:64
buffer_load_dwordx4 v[28:31], v5, s[4:7], 0 offen offset:96
buffer_load_dwordx4 v[32:35], v5, s[4:7], 0 offen offset:128
buffer_load_dwordx4 v[36:39], v5, s[4:7], 0 offen offset:160
buffer_load_dwordx4 v[40:43], v5, s[4:7], 0 offen offset:192
buffer_load_dwordx4 v[44:47], v5, s[4:7], 0 offen offset:224
buffer_load_dwordx4 v[48:51], v5, s[4:7], 0 offen offset:256
buffer_load_dwordx4 v[52:55], v5, s[4:7], 0 offen offset:288
buffer_load_dwordx4 v[56:59], v5, s[4:7], 0 offen offset:320
buffer_load_dwordx4 v[60:63], v5, s[4:7], 0 offen offset:352
buffer_load_dwordx4 v[64:67], v5, s[4:7], 0 offen offset:384
buffer_load_dwordx4 v[68:71], v5, s[4:7], 0 offen offset:416
buffer_load_dwordx4 v[72:75], v5, s[4:7], 0 offen offset:448
buffer_load_dwordx4 v[76:79], v5, s[4:7], 0 offen offset:480
buffer_load_dwordx4 v[80:83], v5, s[4:7], 0 offen offset:512
buffer_load_dwordx4 v[84:87], v5, s[4:7], 0 offen offset:544
buffer_load_dwordx4 v[88:91], v5, s[4:7], 0 offen offset:576
buffer_load_dwordx4 v[92:95], v5, s[4:7], 0 offen offset:608
buffer_load_dwordx4 v[96:99], v5, s[4:7], 0 offen offset:640
buffer_load_dwordx4 v[100:103], v5, s[4:7], 0 offen offset:672
buffer_load_dwordx4 v[104:107], v5, s[4:7], 0 offen offset:704
buffer_load_dwordx4 v[108:111], v5, s[4:7], 0 offen offset:736
buffer_load_dwordx4 v[112:115], v5, s[4:7], 0 offen offset:768
buffer_load_dwordx4 v[116:119], v5, s[4:7], 0 offen offset:800
buffer_load_dwordx4 v[120:123], v5, s[4:7], 0 offen offset:832
buffer_load_dwordx4 v[124:127], v5, s[4:7], 0 offen offset:864
v_and_b32 v6, 15, v1
v_lshrrev_b32 v7, 2, v6
v_lshl_add_u32 v7, v4, 3, v7
v_mul_u32_u24 v9, 128, v7
v_and_b32 v6, 3, v1
v_lshl_add_u32 v9, v6, 3, v9
v_bfe_u32 v6, v1, 4, 1
v_lshl_add_u32 v9, v6, 5, v9
v_accvgpr_write_b32 a0, 0
v_accvgpr_write_b32 a1, 0
v_accvgpr_write_b32 a2, 0
v_accvgpr_write_b32 a3, 0
v_accvgpr_write_b32 a4, 0
v_accvgpr_write_b32 a5, 0
v_accvgpr_write_b32 a6, 0
v_accvgpr_write_b32 a7, 0
v_accvgpr_write_b32 a8, 0
v_accvgpr_write_b32 a9, 0
v_accvgpr_write_b32 a10, 0
v_accvgpr_write_b32 a11, 0
v_accvgpr_write_b32 a12, 0
v_accvgpr_write_b32 a13, 0
v_accvgpr_write_b32 a14, 0
v_accvgpr_write_b32 a15, 0
v_accvgpr_write_b32 a16, 0
v_accvgpr_write_b32 a17, 0
v_accvgpr_write_b32 a18, 0
v_accvgpr_write_b32 a19, 0
v_accvgpr_write_b32 a20, 0
v_accvgpr_write_b32 a21, 0
v_accvgpr_write_b32 a22, 0
v_accvgpr_write_b32 a23, 0
v_accvgpr_write_b32 a24, 0
v_accvgpr_write_b32 a25, 0
v_accvgpr_write_b32 a26, 0
v_accvgpr_write_b32 a27, 0
v_accvgpr_write_b32 a28, 0
v_accvgpr_write_b32 a29, 0
v_accvgpr_write_b32 a30, 0
v_accvgpr_write_b32 a31, 0
s_waitcnt vmcnt(0)
s_barrier
s_mov_b32 s40, 57344
s_mul_i32 s39, s34, 2048
s_add_u32 s39, s39, 8192
s_mov_b32 m0, s39
s_nop 0
buffer_load_dwordx4 v128, s[8:11], s40 offen lds
s_mul_i32 s39, s34, 2048
s_add_u32 s39, s39, 9216
s_mov_b32 m0, s39
s_nop 0
buffer_load_dwordx4 v129, s[8:11], s40 offen lds
ds_read_b64_tr_b16 v[136:137], v9 offset:0
ds_read_b64_tr_b16 v[138:139], v9 offset:512
ds_read_b64_tr_b16 v[140:141], v9 offset:64
ds_read_b64_tr_b16 v[142:143], v9 offset:576
ds_read_b64_tr_b16 v[164:165], v9 offset:2048
ds_read_b64_tr_b16 v[166:167], v9 offset:2560
ds_read_b64_tr_b16 v[168:169], v9 offset:2112
ds_read_b64_tr_b16 v[170:171], v9 offset:2624
s_waitcnt lgkmcnt(4)
v_mfma_f32_32x32x16_bf16 a[0:15], v[136:139], v[16:19], a[0:15]
v_mfma_f32_32x32x16_bf16 a[16:31], v[140:143], v[16:19], a[16:31]
ds_read_b64_tr_b16 v[136:137], v9 offset:4096
ds_read_b64_tr_b16 v[138:139], v9 offset:4608
ds_read_b64_tr_b16 v[140:141], v9 offset:4160
ds_read_b64_tr_b16 v[142:143], v9 offset:4672
s_waitcnt lgkmcnt(4)
v_mfma_f32_32x32x16_bf16 a[0:15], v[164:167], v[20:23], a[0:15]
v_mfma_f32_32x32x16_bf16 a[16:31], v[168:171], v[20:23], a[16:31]
ds_read_b64_tr_b16 v[164:165], v9 offset:6144
ds_read_b64_tr_b16 v[166:167], v9 offset:6656
ds_read_b64_tr_b16 v[168:169], v9 offset:6208
ds_read_b64_tr_b16 v[170:171], v9 offset:6720
s_waitcnt lgkmcnt(4)
v_mfma_f32_32x32x16_bf16 a[0:15], v[136:139], v[24:27], a[0:15]
v_mfma_f32_32x32x16_bf16 a[16:31], v[140:143], v[24:27], a[16:31]
s_waitcnt lgkmcnt(0)
v_mfma_f32_32x32x16_bf16 a[0:15], v[164:167], v[28:31], a[0:15]
v_mfma_f32_32x32x16_bf16 a[16:31], v[168:171], v[28:31], a[16:31]
s_waitcnt vmcnt(0)
s_barrier
s_mov_b32 s40, 114688
s_mul_i32 s39, s34, 2048
s_add_u32 s39, s39, 0
s_mov_b32 m0, s39
s_nop 0
buffer_load_dwordx4 v128, s[8:11], s40 offen lds
s_mul_i32 s39, s34, 2048
s_add_u32 s39, s39, 1024
s_mov_b32 m0, s39
s_nop 0
buffer_load_dwordx4 v129, s[8:11], s40 offen lds
ds_read_b64_tr_b16 v[136:137], v9 offset:8192
ds_read_b64_tr_b16 v[138:139], v9 offset:8704
ds_read_b64_tr_b16 v[140:141], v9 offset:8256
ds_read_b64_tr_b16 v[142:143], v9 offset:8768
ds_read_b64_tr_b16 v[164:165], v9 offset:10240
ds_read_b64_tr_b16 v[166:167], v9 offset:10752
ds_read_b64_tr_b16 v[168:169], v9 offset:10304
ds_read_b64_tr_b16 v[170:171], v9 offset:10816
s_waitcnt lgkmcnt(4)
v_mfma_f32_32x32x16_bf16 a[0:15], v[136:139], v[32:35], a[0:15]
v_mfma_f32_32x32x16_bf16 a[16:31], v[140:143], v[32:35], a[16:31]
ds_read_b64_tr_b16 v[136:137], v9 offset:12288
ds_read_b64_tr_b16 v[138:139], v9 offset:12800
ds_read_b64_tr_b16 v[140:141], v9 offset:12352
ds_read_b64_tr_b16 v[142:143], v9 offset:12864
s_waitcnt lgkmcnt(4)
v_mfma_f32_32x32x16_bf16 a[0:15], v[164:167], v[36:39], a[0:15]
v_mfma_f32_32x32x16_bf16 a[16:31], v[168:171], v[36:39], a[16:31]
ds_read_b64_tr_b16 v[164:165], v9 offset:14336
ds_read_b64_tr_b16 v[166:167], v9 offset:14848
ds_read_b64_tr_b16 v[168:169], v9 offset:14400
ds_read_b64_tr_b16 v[170:171], v9 offset:14912
s_waitcnt lgkmcnt(4)
v_mfma_f32_32x32x16_bf16 a[0:15], v[136:139], v[40:43], a[0:15]
v_mfma_f32_32x32x16_bf16 a[16:31], v[140:143], v[40:43], a[16:31]
s_waitcnt lgkmcnt(0)
v_mfma_f32_32x32x16_bf16 a[0:15], v[164:167], v[44:47], a[0:15]
v_mfma_f32_32x32x16_bf16 a[16:31], v[168:171], v[44:47], a[16:31]
s_waitcnt vmcnt(0)
s_barrier
s_mov_b32 s40, 172032
s_mul_i32 s39, s34, 2048
s_add_u32 s39, s39, 8192
s_mov_b32 m0, s39
s_nop 0
buffer_load_dwordx4 v128, s[8:11], s40 offen lds
s_mul_i32 s39, s34, 2048
s_add_u32 s39, s39, 9216
s_mov_b32 m0, s39
s_nop 0
buffer_load_dwordx4 v129, s[8:11], s40 offen lds
ds_read_b64_tr_b16 v[136:137], v9 offset:0
ds_read_b64_tr_b16 v[138:139], v9 offset:512
ds_read_b64_tr_b16 v[140:141], v9 offset:64
ds_read_b64_tr_b16 v[142:143], v9 offset:576
ds_read_b64_tr_b16 v[164:165], v9 offset:2048
ds_read_b64_tr_b16 v[166:167], v9 offset:2560
ds_read_b64_tr_b16 v[168:169], v9 offset:2112
ds_read_b64_tr_b16 v[170:171], v9 offset:2624
s_waitcnt lgkmcnt(4)
v_mfma_f32_32x32x16_bf16 a[0:15], v[136:139], v[48:51], a[0:15]
v_mfma_f32_32x32x16_bf16 a[16:31], v[140:143], v[48:51], a[16:31]
ds_read_b64_tr_b16 v[136:137], v9 offset:4096
ds_read_b64_tr_b16 v[138:139], v9 offset:4608
ds_read_b64_tr_b16 v[140:141], v9 offset:4160
ds_read_b64_tr_b16 v[142:143], v9 offset:4672
s_waitcnt lgkmcnt(4)
v_mfma_f32_32x32x16_bf16 a[0:15], v[164:167], v[52:55], a[0:15]
v_mfma_f32_32x32x16_bf16 a[16:31], v[168:171], v[52:55], a[16:31]
ds_read_b64_tr_b16 v[164:165], v9 offset:6144
ds_read_b64_tr_b16 v[166:167], v9 offset:6656
ds_read_b64_tr_b16 v[168:169], v9 offset:6208
ds_read_b64_tr_b16 v[170:171], v9 offset:6720
s_waitcnt lgkmcnt(4)
v_mfma_f32_32x32x16_bf16 a[0:15], v[136:139], v[56:59], a[0:15]
v_mfma_f32_32x32x16_bf16 a[16:31], v[140:143], v[56:59], a[16:31]
s_waitcnt lgkmcnt(0)
v_mfma_f32_32x32x16_bf16 a[0:15], v[164:167], v[60:63], a[0:15]
v_mfma_f32_32x32x16_bf16 a[16:31], v[168:171], v[60:63], a[16:31]
s_waitcnt vmcnt(0)
s_barrier
s_mov_b32 s40, 229376
s_mul_i32 s39, s34, 2048
s_add_u32 s39, s39, 0
s_mov_b32 m0, s39
s_nop 0
buffer_load_dwordx4 v128, s[8:11], s40 offen lds
s_mul_i32 s39, s34, 2048
s_add_u32 s39, s39, 1024
s_mov_b32 m0, s39
s_nop 0
buffer_load_dwordx4 v129, s[8:11], s40 offen lds
ds_read_b64_tr_b16 v[136:137], v9 offset:8192
ds_read_b64_tr_b16 v[138:139], v9 offset:8704
ds_read_b64_tr_b16 v[140:141], v9 offset:8256
ds_read_b64_tr_b16 v[142:143], v9 offset:8768
ds_read_b64_tr_b16 v[164:165], v9 offset:10240
ds_read_b64_tr_b16 v[166:167], v9 offset:10752
ds_read_b64_tr_b16 v[168:169], v9 offset:10304
ds_read_b64_tr_b16 v[170:171], v9 offset:10816
s_waitcnt lgkmcnt(4)
v_mfma_f32_32x32x16_bf16 a[0:15], v[136:139], v[64:67], a[0:15]
v_mfma_f32_32x32x16_bf16 a[16:31], v[140:143], v[64:67], a[16:31]
ds_read_b64_tr_b16 v[136:137], v9 offset:12288
ds_read_b64_tr_b16 v[138:139], v9 offset:12800
ds_read_b64_tr_b16 v[140:141], v9 offset:12352
ds_read_b64_tr_b16 v[142:143], v9 offset:12864
s_waitcnt lgkmcnt(4)
v_mfma_f32_32x32x16_bf16 a[0:15], v[164:167], v[68:71], a[0:15]
v_mfma_f32_32x32x16_bf16 a[16:31], v[168:171], v[68:71], a[16:31]
ds_read_b64_tr_b16 v[164:165], v9 offset:14336
ds_read_b64_tr_b16 v[166:167], v9 offset:14848
ds_read_b64_tr_b16 v[168:169], v9 offset:14400
ds_read_b64_tr_b16 v[170:171], v9 offset:14912
s_waitcnt lgkmcnt(4)
v_mfma_f32_32x32x16_bf16 a[0:15], v[136:139], v[72:75], a[0:15]
v_mfma_f32_32x32x16_bf16 a[16:31], v[140:143], v[72:75], a[16:31]
s_waitcnt lgkmcnt(0)
v_mfma_f32_32x32x16_bf16 a[0:15], v[164:167], v[76:79], a[0:15]
v_mfma_f32_32x32x16_bf16 a[16:31], v[168:171], v[76:79], a[16:31]
s_waitcnt vmcnt(0)
s_barrier
s_mov_b32 s40, 286720
s_mul_i32 s39, s34, 2048
s_add_u32 s39, s39, 8192
s_mov_b32 m0, s39
s_nop 0
buffer_load_dwordx4 v128, s[8:11], s40 offen lds
s_mul_i32 s39, s34, 2048
s_add_u32 s39, s39, 9216
s_mov_b32 m0, s39
s_nop 0
buffer_load_dwordx4 v129, s[8:11], s40 offen lds
ds_read_b64_tr_b16 v[136:137], v9 offset:0
ds_read_b64_tr_b16 v[138:139], v9 offset:512
ds_read_b64_tr_b16 v[140:141], v9 offset:64
ds_read_b64_tr_b16 v[142:143], v9 offset:576
ds_read_b64_tr_b16 v[164:165], v9 offset:2048
ds_read_b64_tr_b16 v[166:167], v9 offset:2560
ds_read_b64_tr_b16 v[168:169], v9 offset:2112
ds_read_b64_tr_b16 v[170:171], v9 offset:2624
s_waitcnt lgkmcnt(4)
v_mfma_f32_32x32x16_bf16 a[0:15], v[136:139], v[80:83], a[0:15]
v_mfma_f32_32x32x16_bf16 a[16:31], v[140:143], v[80:83], a[16:31]
ds_read_b64_tr_b16 v[136:137], v9 offset:4096
ds_read_b64_tr_b16 v[138:139], v9 offset:4608
ds_read_b64_tr_b16 v[140:141], v9 offset:4160
ds_read_b64_tr_b16 v[142:143], v9 offset:4672
s_waitcnt lgkmcnt(4)
v_mfma_f32_32x32x16_bf16 a[0:15], v[164:167], v[84:87], a[0:15]
v_mfma_f32_32x32x16_bf16 a[16:31], v[168:171], v[84:87], a[16:31]
ds_read_b64_tr_b16 v[164:165], v9 offset:6144
ds_read_b64_tr_b16 v[166:167], v9 offset:6656
ds_read_b64_tr_b16 v[168:169], v9 offset:6208
ds_read_b64_tr_b16 v[170:171], v9 offset:6720
s_waitcnt lgkmcnt(4)
v_mfma_f32_32x32x16_bf16 a[0:15], v[136:139], v[88:91], a[0:15]
v_mfma_f32_32x32x16_bf16 a[16:31], v[140:143], v[88:91], a[16:31]
s_waitcnt lgkmcnt(0)
v_mfma_f32_32x32x16_bf16 a[0:15], v[164:167], v[92:95], a[0:15]
v_mfma_f32_32x32x16_bf16 a[16:31], v[168:171], v[92:95], a[16:31]
s_waitcnt vmcnt(0)
s_barrier
s_mov_b32 s40, 344064
s_mul_i32 s39, s34, 2048
s_add_u32 s39, s39, 0
s_mov_b32 m0, s39
s_nop 0
buffer_load_dwordx4 v128, s[8:11], s40 offen lds
s_mul_i32 s39, s34, 2048
s_add_u32 s39, s39, 1024
s_mov_b32 m0, s39
s_nop 0
buffer_load_dwordx4 v129, s[8:11], s40 offen lds
ds_read_b64_tr_b16 v[136:137], v9 offset:8192
ds_read_b64_tr_b16 v[138:139], v9 offset:8704
ds_read_b64_tr_b16 v[140:141], v9 offset:8256
ds_read_b64_tr_b16 v[142:143], v9 offset:8768
ds_read_b64_tr_b16 v[164:165], v9 offset:10240
ds_read_b64_tr_b16 v[166:167], v9 offset:10752
ds_read_b64_tr_b16 v[168:169], v9 offset:10304
ds_read_b64_tr_b16 v[170:171], v9 offset:10816
s_waitcnt lgkmcnt(4)
v_mfma_f32_32x32x16_bf16 a[0:15], v[136:139], v[96:99], a[0:15]
v_mfma_f32_32x32x16_bf16 a[16:31], v[140:143], v[96:99], a[16:31]
ds_read_b64_tr_b16 v[136:137], v9 offset:12288
ds_read_b64_tr_b16 v[138:139], v9 offset:12800
ds_read_b64_tr_b16 v[140:141], v9 offset:12352
ds_read_b64_tr_b16 v[142:143], v9 offset:12864
s_waitcnt lgkmcnt(4)
v_mfma_f32_32x32x16_bf16 a[0:15], v[164:167], v[100:103], a[0:15]
v_mfma_f32_32x32x16_bf16 a[16:31], v[168:171], v[100:103], a[16:31]
ds_read_b64_tr_b16 v[164:165], v9 offset:14336
ds_read_b64_tr_b16 v[166:167], v9 offset:14848
ds_read_b64_tr_b16 v[168:169], v9 offset:14400
ds_read_b64_tr_b16 v[170:171], v9 offset:14912
s_waitcnt lgkmcnt(4)
v_mfma_f32_32x32x16_bf16 a[0:15], v[136:139], v[104:107], a[0:15]
v_mfma_f32_32x32x16_bf16 a[16:31], v[140:143], v[104:107], a[16:31]
s_waitcnt lgkmcnt(0)
v_mfma_f32_32x32x16_bf16 a[0:15], v[164:167], v[108:111], a[0:15]
v_mfma_f32_32x32x16_bf16 a[16:31], v[168:171], v[108:111], a[16:31]
s_waitcnt vmcnt(0)
s_barrier
ds_read_b64_tr_b16 v[136:137], v9 offset:0
ds_read_b64_tr_b16 v[138:139], v9 offset:512
ds_read_b64_tr_b16 v[140:141], v9 offset:64
ds_read_b64_tr_b16 v[142:143], v9 offset:576
ds_read_b64_tr_b16 v[164:165], v9 offset:2048
ds_read_b64_tr_b16 v[166:167], v9 offset:2560
ds_read_b64_tr_b16 v[168:169], v9 offset:2112
ds_read_b64_tr_b16 v[170:171], v9 offset:2624
s_waitcnt lgkmcnt(4)
v_mfma_f32_32x32x16_bf16 a[0:15], v[136:139], v[112:115], a[0:15]
v_mfma_f32_32x32x16_bf16 a[16:31], v[140:143], v[112:115], a[16:31]
ds_read_b64_tr_b16 v[136:137], v9 offset:4096
ds_read_b64_tr_b16 v[138:139], v9 offset:4608
ds_read_b64_tr_b16 v[140:141], v9 offset:4160
ds_read_b64_tr_b16 v[142:143], v9 offset:4672
s_waitcnt lgkmcnt(4)
v_mfma_f32_32x32x16_bf16 a[0:15], v[164:167], v[116:119], a[0:15]
v_mfma_f32_32x32x16_bf16 a[16:31], v[168:171], v[116:119], a[16:31]
ds_read_b64_tr_b16 v[164:165], v9 offset:6144
ds_read_b64_tr_b16 v[166:167], v9 offset:6656
ds_read_b64_tr_b16 v[168:169], v9 offset:6208
ds_read_b64_tr_b16 v[170:171], v9 offset:6720
s_waitcnt lgkmcnt(4)
v_mfma_f32_32x32x16_bf16 a[0:15], v[136:139], v[120:123], a[0:15]
v_mfma_f32_32x32x16_bf16 a[16:31], v[140:143], v[120:123], a[16:31]
s_waitcnt lgkmcnt(0)
v_mfma_f32_32x32x16_bf16 a[0:15], v[164:167], v[124:127], a[0:15]
v_mfma_f32_32x32x16_bf16 a[16:31], v[168:171], v[124:127], a[16:31]
s_nop 15
s_nop 7
v_accvgpr_read_b32 v16, a0
v_accvgpr_read_b32 v17, a1
v_accvgpr_read_b32 v18, a2
v_accvgpr_read_b32 v19, a3
v_accvgpr_read_b32 v20, a4
v_accvgpr_read_b32 v21, a5
v_accvgpr_read_b32 v22, a6
v_accvgpr_read_b32 v23, a7
v_accvgpr_read_b32 v24, a8
v_accvgpr_read_b32 v25, a9
v_accvgpr_read_b32 v26, a10
v_accvgpr_read_b32 v27, a11
v_accvgpr_read_b32 v28, a12
v_accvgpr_read_b32 v29, a13
v_accvgpr_read_b32 v30, a14
v_accvgpr_read_b32 v31, a15
v_accvgpr_read_b32 v32, a16
v_accvgpr_read_b32 v33, a17
v_accvgpr_read_b32 v34, a18
v_accvgpr_read_b32 v35, a19
v_accvgpr_read_b32 v36, a20
v_accvgpr_read_b32 v37, a21
v_accvgpr_read_b32 v38, a22
v_accvgpr_read_b32 v39, a23
v_accvgpr_read_b32 v40, a24
v_accvgpr_read_b32 v41, a25
v_accvgpr_read_b32 v42, a26
v_accvgpr_read_b32 v43, a27
v_accvgpr_read_b32 v44, a28
v_accvgpr_read_b32 v45, a29
v_accvgpr_read_b32 v46, a30
v_accvgpr_read_b32 v47, a31
s_lshl_b32 s36, s35, 5
v_add_u32 v5, s36, v3
v_mul_u32_u24 v5, 1792, v5
v_lshl_add_u32 v5, v4, 3, v5
s_mul_i32 s42, s20, 896
s_lshl_b32 s43, s22, 7
s_add_u32 s42, s42, s43
v_cvt_pk_bf16_f32 v16, v16, v17
v_cvt_pk_bf16_f32 v17, v18, v19
buffer_store_dwordx2 v[16:17], v5, s[16:19], s42 offen offset:0
v_cvt_pk_bf16_f32 v20, v20, v21
v_cvt_pk_bf16_f32 v21, v22, v23
buffer_store_dwordx2 v[20:21], v5, s[16:19], s42 offen offset:16
v_cvt_pk_bf16_f32 v24, v24, v25
v_cvt_pk_bf16_f32 v25, v26, v27
buffer_store_dwordx2 v[24:25], v5, s[16:19], s42 offen offset:32
v_cvt_pk_bf16_f32 v28, v28, v29
v_cvt_pk_bf16_f32 v29, v30, v31
buffer_store_dwordx2 v[28:29], v5, s[16:19], s42 offen offset:48
v_cvt_pk_bf16_f32 v32, v32, v33
v_cvt_pk_bf16_f32 v33, v34, v35
buffer_store_dwordx2 v[32:33], v5, s[16:19], s42 offen offset:64
v_cvt_pk_bf16_f32 v36, v36, v37
v_cvt_pk_bf16_f32 v37, v38, v39
buffer_store_dwordx2 v[36:37], v5, s[16:19], s42 offen offset:80
v_cvt_pk_bf16_f32 v40, v40, v41
v_cvt_pk_bf16_f32 v41, v42, v43
buffer_store_dwordx2 v[40:41], v5, s[16:19], s42 offen offset:96
v_cvt_pk_bf16_f32 v44, v44, v45
v_cvt_pk_bf16_f32 v45, v46, v47
buffer_store_dwordx2 v[44:45], v5, s[16:19], s42 offen offset:112
oproj_kernel_end:
s_endpgm
.section .rodata,"a"
.p2align 6
.amdhsa_kernel qkv_kernel
.amdhsa_next_free_vgpr 304
.amdhsa_next_free_sgpr 64
.amdhsa_accum_offset 192
.amdhsa_group_segment_fixed_size 0
.amdhsa_kernarg_size 72
.amdhsa_user_sgpr_count 2
.amdhsa_user_sgpr_kernarg_segment_ptr 1
.amdhsa_system_sgpr_workgroup_id_x 1
.end_amdhsa_kernel
.p2align 6
.amdhsa_kernel attn_kernel
.amdhsa_next_free_vgpr 112
.amdhsa_next_free_sgpr 64
.amdhsa_accum_offset 112
.amdhsa_group_segment_fixed_size 0
.amdhsa_kernarg_size 72
.amdhsa_user_sgpr_count 2
.amdhsa_user_sgpr_kernarg_segment_ptr 1
.amdhsa_system_sgpr_workgroup_id_x 1
.end_amdhsa_kernel
.p2align 6
.amdhsa_kernel oproj_kernel
.amdhsa_next_free_vgpr 224
.amdhsa_next_free_sgpr 64
.amdhsa_accum_offset 192
.amdhsa_group_segment_fixed_size 0
.amdhsa_kernarg_size 72
.amdhsa_user_sgpr_count 2
.amdhsa_user_sgpr_kernarg_segment_ptr 1
.amdhsa_system_sgpr_workgroup_id_x 1
.end_amdhsa_kernel
```
